```python
import torch

def _softmax(x, axis=-1):
    return torch.softmax(x, dim=axis)

def _gelu(x):
    return torch.nn.functional.gelu(x, approximate='tanh')

def _silu(x):
    return torch.nn.functional.silu(x)

def _sigmoid(x):
    return torch.sigmoid(x)

def _layernorm(x, axis=-1, eps=1e-05):
    m = x.mean(dim=axis, keepdim=True)
    v = x.var(dim=axis, keepdim=True, unbiased=False)
    return (x - m) / torch.sqrt(v + eps)

def _scatter_add(tgt, idx, src, axis=0):
    return tgt.clone().index_add_(axis, idx, src)

def _segment_sum(src, seg, n):
    out = torch.zeros((n,) + src.shape[1:], dtype=src.dtype)
    return out.index_add_(0, seg, src)

def _pad(x, pw):
    flat = tuple((v for pair in reversed(pw) for v in pair))
    return torch.nn.functional.pad(x, flat)
kernel_name = 'adaLN_cond__compressed_kv_cla__glu_gated_glu__decode'

def setup_inputs():

    _w = lambda a: (lambda t: t.to(torch.bfloat16) if t.is_floating_point() else t)(torch.as_tensor(a))

    def _A_setup():
        B, H, Sq, Sk, D, M = (2, 32, 1, 4096, 128, 640)
        Dc = 4 * D
        return {'x': _w((lambda *s: torch.randn(*s, dtype=torch.bfloat16) * 0.05)(B, Sq, M)), 'c_kv': _w((lambda *s: torch.randn(*s, dtype=torch.bfloat16) * 1.6)(B, Sk, Dc)), 'w_q': _w((lambda *s: torch.randn(*s, dtype=torch.bfloat16) * 0.8)(M, H, D) * M ** (-0.5)), 'w_uk': _w((lambda *s: torch.randn(*s, dtype=torch.bfloat16) * 0.8)(Dc, H, D) * Dc ** (-0.5)), 'w_uv': _w((lambda *s: torch.randn(*s, dtype=torch.bfloat16) * 1.6)(Dc, H, D) * Dc ** (-0.5)), 'w_o': _w((lambda *s: torch.randn(*s, dtype=torch.bfloat16) * 1.6)(H, D, M) * (H * D) ** (-0.5))}
    _A_in = _A_setup()

    def _B_setup():
        B, S, D, F = (2, 1, 640, 1728)
        return {'x': _w((lambda *s: torch.randn(*s, dtype=torch.bfloat16) * 0.05)(B, S, D)), 'w_gate': _w((lambda *s: torch.randn(*s, dtype=torch.bfloat16) * 0.05)(D, F)), 'w_up': _w((lambda *s: torch.randn(*s, dtype=torch.bfloat16) * 0.05)(D, F)), 'w_down': _w((lambda *s: torch.randn(*s, dtype=torch.bfloat16) * 0.05)(F, D))}
    _B_in = _B_setup()
    return {'A_x': _A_in['x'], 'A_c_kv': _A_in['c_kv'], 'A_w_q': _A_in['w_q'], 'A_w_uk': _A_in['w_uk'], 'A_w_uv': _A_in['w_uv'], 'A_w_o': _A_in['w_o'], 'B_x': _B_in['x'], 'B_w_gate': _B_in['w_gate'], 'B_w_up': _B_in['w_up'], 'B_w_down': _B_in['w_down'], 'c': _w((lambda *s: torch.randn(*s, dtype=torch.bfloat16) * 0.1)(2, 640) * 8.0), 'w_mod': _w((lambda *s: torch.randn(*s, dtype=torch.bfloat16) * 0.1)(640, 6 * 640) * 640 ** (-0.5) * 8.0)}

def reference(A_x, A_c_kv, A_w_q, A_w_uk, A_w_uv, A_w_o, B_x, B_w_gate, B_w_up, B_w_down, c, w_mod):

    def _A_ref(x, c_kv, w_q, w_uk, w_uv, w_o):
        B, Sq, M = (x.shape[0], x.shape[1], x.shape[2])
        Sk = c_kv.shape[1]
        H, D = (w_q.shape[1], w_q.shape[2])
        q = torch.einsum('bqm,mhd->bhqd', x, w_q)
        k = torch.einsum('bkc,chd->bhkd', c_kv, w_uk)
        v = torch.einsum('bkc,chd->bhkd', c_kv, w_uv)
        scores = torch.einsum('bhqd,bhkd->bhqk', q, k) * D ** (-0.5)
        off = Sk - Sq
        qi = torch.arange(Sq)[:, None]
        kj = torch.arange(Sk)[None, :]
        cmask = kj <= qi + off
        scores = torch.where(cmask[None, None], scores, -1000000000.0)
        p = _softmax(scores, axis=-1)
        ctx = torch.einsum('bhqk,bhkd->bhqd', p, v)
        return torch.einsum('bhqd,hdm->bqm', ctx, w_o)

    def _B_ref(x, w_gate, w_up, w_down):
        g = torch.einsum('bsd,df->bsf', x, w_gate)
        u = torch.einsum('bsd,df->bsf', x, w_up)
        h = _sigmoid(g) * u
        return torch.einsum('bsf,fd->bsd', h, w_down)
    x = A_x
    mod = (_silu(c) @ w_mod).reshape(c.shape[0], 6, 1, -1)
    sa, ca, ga, sb, cb, gb = (mod[:, 0].clone(), mod[:, 1].clone(), mod[:, 2].clone(), mod[:, 3].clone(), mod[:, 4].clone(), mod[:, 5].clone())
    h = _layernorm(x, axis=-1) * (1 + ca) + sa
    x = x + ga * _A_ref(h, A_c_kv, A_w_q, A_w_uk, A_w_uv, A_w_o)
    h = _layernorm(x, axis=-1) * (1 + cb) + sb
    x = x + gb * _B_ref(h, B_w_gate, B_w_up, B_w_down)
    return x
```

```asm
; @launch grid=(256,1,1) block=(256,1,1) lds=163840
.amdgcn_target "amdgcn-amd-amdhsa--gfx950"
.text
.globl adaLN_cond__compressed_kv_cla__glu_gated_glu__decode_kernel
.p2align 8
.type adaLN_cond__compressed_kv_cla__glu_gated_glu__decode_kernel,@function
adaLN_cond__compressed_kv_cla__glu_gated_glu__decode_kernel:
  s_getpc_b64 s[4:5]
  s_cmp_ge_u32 s2, 256
  s_cbranch_scc1 L_END
  s_load_dwordx2 s[8:9], s[0:1], 112
  s_mov_b32 s10, 268435456
  s_mov_b32 s11, 0x20000
  v_lshrrev_b32 v6, 6, v0
  v_and_b32 v1, 63, v0
  v_and_b32 v2, 15, v0
  v_bfe_u32 v3, v0, 4, 2
  v_mov_b32 v5, 0
  v_readfirstlane_b32 s3, v6
  s_and_b32 s17, s2, 7
  s_mov_b32 s14, 0xff
  s_mov_b32 s15, 0
  s_mov_b32 s16, s2
  s_cmp_lt_u32 s2, 80
  s_cbranch_scc1 L_DG
  s_sub_u32 s16, s2, 128
  s_cmp_ge_u32 s2, 208
  s_cbranch_scc1 L_DG
  s_sub_u32 s16, s2, 80
  s_load_dwordx2 s[24:25], s[0:1], 0
  s_mov_b32 s26, 2560
  s_mov_b32 s27, 0x20000
  s_load_dwordx2 s[28:29], s[0:1], 16
  s_mov_b32 s30, 5242880
  s_mov_b32 s31, 0x20000
  s_load_dwordx2 s[32:33], s[0:1], 24
  s_mov_b32 s34, 4194304
  s_mov_b32 s35, 0x20000
  s_load_dwordx2 s[36:37], s[0:1], 32
  s_mov_b32 s38, 4194304
  s_mov_b32 s39, 0x20000
  s_load_dwordx2 s[40:41], s[0:1], 80
  s_mov_b32 s42, 2560
  s_mov_b32 s43, 0x20000
  s_load_dwordx2 s[52:53], s[0:1], 88
  s_mov_b32 s54, 4915200
  s_mov_b32 s55, 0x20000
  s_lshr_b32 s19, s16, 2
  s_and_b32 s20, s16, 3
  v_lshlrev_b32 v10, 13, v3
  v_lshl_add_u32 v10, v2, 4, v10
  v_lshlrev_b32 v11, 13, v2
  v_lshl_add_u32 v11, v3, 4, v11
  v_lshlrev_b32 v12, 16, v3
  v_lshl_add_u32 v12, v2, 4, v12
  s_waitcnt lgkmcnt(0)
  s_and_b32 s56, s3, 1
  s_mul_i32 s57, s56, 1280
  v_lshlrev_b32 v6, 2, v1
  buffer_load_dword v14, v6, s[24:27], s57 offen offset:0
  buffer_load_dword v15, v6, s[24:27], s57 offen offset:256
  buffer_load_dword v16, v6, s[24:27], s57 offen offset:512
  buffer_load_dword v17, v6, s[24:27], s57 offen offset:768
  buffer_load_dword v18, v6, s[24:27], s57 offen offset:1024
  s_mul_i32 s58, s20, 320
  s_add_u32 s58, s58, s57
  v_lshlrev_b32 v7, 3, v1
  buffer_load_dwordx2 v[20:21], v7, s[24:27], s58 offen
  s_cmp_ge_u32 s16, 40
  s_cselect_b32 s22, 1, 0
  s_mul_i32 s48, s22, 40
  s_sub_u32 s21, s16, s48
  s_lshr_b32 s48, s3, 1
  s_lshl_b32 s48, s48, 9
  s_mul_i32 s59, s22, 640
  s_add_u32 s59, s59, s48
  s_add_u32 s59, s59, s57
  buffer_load_dwordx2 v[22:23], v7, s[40:43], s59 offen
  s_mul_i32 s49, s20, 1310720
  s_lshl_b32 s50, s19, 8
  s_add_u32 s49, s49, s50
  s_lshl_b32 s51, s3, 15
  s_add_u32 s49, s49, s51
  buffer_load_dwordx4 v[64:67], v10, s[28:31], s49 offen nt
  s_add_u32 s49, s49, 131072
  buffer_load_dwordx4 v[68:71], v10, s[28:31], s49 offen nt
  s_add_u32 s49, s49, 131072
  buffer_load_dwordx4 v[72:75], v10, s[28:31], s49 offen nt
  s_add_u32 s49, s49, 131072
  buffer_load_dwordx4 v[76:79], v10, s[28:31], s49 offen nt
  s_add_u32 s49, s49, 131072
  buffer_load_dwordx4 v[80:83], v10, s[28:31], s49 offen nt
  s_add_u32 s49, s49, 131072
  buffer_load_dwordx4 v[84:87], v10, s[28:31], s49 offen nt
  s_add_u32 s49, s49, 131072
  buffer_load_dwordx4 v[88:91], v10, s[28:31], s49 offen nt
  s_add_u32 s49, s49, 131072
  buffer_load_dwordx4 v[92:95], v10, s[28:31], s49 offen nt
  s_add_u32 s49, s49, 131072
  buffer_load_dwordx4 v[96:99], v10, s[28:31], s49 offen nt
  s_add_u32 s49, s49, 131072
  buffer_load_dwordx4 v[100:103], v10, s[28:31], s49 offen nt
  v_lshlrev_b32 v54, 13, v3
  v_lshl_add_u32 v54, v2, 4, v54
  s_lshl_b32 s49, s20, 20
  s_add_u32 s49, s49, s50
  s_lshl_b32 s51, s3, 18
  s_add_u32 s49, s49, s51
  s_lshl_b32 s51, s3, 13
  s_add_u32 s51, s51, 32768
  s_mov_b32 m0, s51
  s_add_u32 s51, s51, 1024
  buffer_load_dwordx4 v54, s[32:35], s49 offen nt lds
  s_add_u32 s49, s49, 32768
  s_mov_b32 m0, s51
  s_add_u32 s51, s51, 1024
  buffer_load_dwordx4 v54, s[32:35], s49 offen nt lds
  s_add_u32 s49, s49, 32768
  s_mov_b32 m0, s51
  s_add_u32 s51, s51, 1024
  buffer_load_dwordx4 v54, s[32:35], s49 offen nt lds
  s_add_u32 s49, s49, 32768
  s_mov_b32 m0, s51
  s_add_u32 s51, s51, 1024
  buffer_load_dwordx4 v54, s[32:35], s49 offen nt lds
  s_add_u32 s49, s49, 32768
  s_mov_b32 m0, s51
  s_add_u32 s51, s51, 1024
  buffer_load_dwordx4 v54, s[32:35], s49 offen nt lds
  s_add_u32 s49, s49, 32768
  s_mov_b32 m0, s51
  s_add_u32 s51, s51, 1024
  buffer_load_dwordx4 v54, s[32:35], s49 offen nt lds
  s_add_u32 s49, s49, 32768
  s_mov_b32 m0, s51
  s_add_u32 s51, s51, 1024
  buffer_load_dwordx4 v54, s[32:35], s49 offen nt lds
  s_add_u32 s49, s49, 32768
  s_mov_b32 m0, s51
  s_add_u32 s51, s51, 1024
  buffer_load_dwordx4 v54, s[32:35], s49 offen nt lds
  s_add_u32 s49, s49, 32768
  s_load_dword s12, s[8:9], 0
  v_and_b32 v6, 7, v2
  v_and_b32 v7, 1, v6
  v_lshrrev_b32 v6, 1, v6
  v_cmp_eq_u32 vcc, 1, v7
  v_mov_b32 v8, 0xffff
  v_mov_b32 v9, 0xffff0000
  v_cndmask_b32 v7, v8, v9, vcc
  v_cmp_eq_u32 vcc, 0, v6
  s_nop 1
  v_cndmask_b32 v24, 0, v7, vcc
  v_cmp_eq_u32 vcc, 1, v6
  s_nop 1
  v_cndmask_b32 v25, 0, v7, vcc
  v_cmp_eq_u32 vcc, 2, v6
  s_nop 1
  v_cndmask_b32 v26, 0, v7, vcc
  v_cmp_eq_u32 vcc, 3, v6
  s_nop 1
  v_cndmask_b32 v27, 0, v7, vcc
  s_waitcnt vmcnt(20)
  v_lshlrev_b32 v30, 16, v14
  v_and_b32 v31, 0xffff0000, v14
  v_lshlrev_b32 v32, 16, v15
  v_and_b32 v33, 0xffff0000, v15
  v_lshlrev_b32 v34, 16, v16
  v_and_b32 v35, 0xffff0000, v16
  v_lshlrev_b32 v36, 16, v17
  v_and_b32 v37, 0xffff0000, v17
  v_lshlrev_b32 v38, 16, v18
  v_and_b32 v39, 0xffff0000, v18
  v_add_f32 v40, v30, v31
  v_add_f32 v40, v40, v32
  v_add_f32 v40, v40, v33
  v_add_f32 v40, v40, v34
  v_add_f32 v40, v40, v35
  v_add_f32 v40, v40, v36
  v_add_f32 v40, v40, v37
  v_add_f32 v40, v40, v38
  v_add_f32 v40, v40, v39
  s_nop 1
  v_add_f32_dpp v40, v40, v40 quad_perm:[1,0,3,2] row_mask:0xf bank_mask:0xf
  s_nop 1
  v_add_f32_dpp v40, v40, v40 quad_perm:[2,3,0,1] row_mask:0xf bank_mask:0xf
  s_nop 1
  v_add_f32_dpp v40, v40, v40 row_half_mirror row_mask:0xf bank_mask:0xf
  s_nop 1
  v_add_f32_dpp v40, v40, v40 row_mirror row_mask:0xf bank_mask:0xf
  v_mov_b32 v41, v40
  s_nop 1
  v_permlane16_swap_b32 v40, v41
  v_add_f32 v40, v40, v41
  v_mov_b32 v41, v40
  s_nop 1
  v_permlane32_swap_b32 v40, v41
  v_add_f32 v40, v40, v41
  v_mul_f32 v40, 0x3acccccd, v40
  v_sub_f32 v30, v30, v40
  v_sub_f32 v31, v31, v40
  v_sub_f32 v32, v32, v40
  v_sub_f32 v33, v33, v40
  v_sub_f32 v34, v34, v40
  v_sub_f32 v35, v35, v40
  v_sub_f32 v36, v36, v40
  v_sub_f32 v37, v37, v40
  v_sub_f32 v38, v38, v40
  v_sub_f32 v39, v39, v40
  v_mul_f32 v42, v30, v30
  v_fmac_f32 v42, v31, v31
  v_fmac_f32 v42, v32, v32
  v_fmac_f32 v42, v33, v33
  v_fmac_f32 v42, v34, v34
  v_fmac_f32 v42, v35, v35
  v_fmac_f32 v42, v36, v36
  v_fmac_f32 v42, v37, v37
  v_fmac_f32 v42, v38, v38
  v_fmac_f32 v42, v39, v39
  s_nop 1
  v_add_f32_dpp v42, v42, v42 quad_perm:[1,0,3,2] row_mask:0xf bank_mask:0xf
  s_nop 1
  v_add_f32_dpp v42, v42, v42 quad_perm:[2,3,0,1] row_mask:0xf bank_mask:0xf
  s_nop 1
  v_add_f32_dpp v42, v42, v42 row_half_mirror row_mask:0xf bank_mask:0xf
  s_nop 1
  v_add_f32_dpp v42, v42, v42 row_mirror row_mask:0xf bank_mask:0xf
  v_mov_b32 v41, v42
  s_nop 1
  v_permlane16_swap_b32 v42, v41
  v_add_f32 v42, v42, v41
  v_mov_b32 v41, v42
  s_nop 1
  v_permlane32_swap_b32 v42, v41
  v_add_f32 v42, v42, v41
  v_mul_f32 v42, 0x3acccccd, v42
  v_cvt_pk_bf16_f32 v42, v42, v42
  v_and_b32 v42, 0xffff0000, v42
  v_add_f32 v42, 0x3727c5ac, v42
  v_cvt_pk_bf16_f32 v42, v42, v42
  v_and_b32 v42, 0xffff0000, v42
  v_sqrt_f32 v42, v42
  s_nop 0
  v_cvt_pk_bf16_f32 v42, v42, v42
  v_and_b32 v42, 0xffff0000, v42
  v_rcp_f32 v42, v42
  v_cvt_pk_bf16_f32 v40, v40, v40
  v_and_b32 v40, 0xffff0000, v40
  s_waitcnt vmcnt(19)
  v_lshlrev_b32 v44, 16, v20
  v_and_b32 v45, 0xffff0000, v20
  v_lshlrev_b32 v46, 16, v21
  v_and_b32 v47, 0xffff0000, v21
  v_sub_f32 v44, v44, v40
  v_cvt_pk_bf16_f32 v44, v44, v44
  v_and_b32 v44, 0xffff0000, v44
  v_mul_f32 v44, v44, v42
  v_cvt_pk_bf16_f32 v44, v44, v44
  v_and_b32 v44, 0xffff0000, v44
  v_sub_f32 v45, v45, v40
  v_cvt_pk_bf16_f32 v45, v45, v45
  v_and_b32 v45, 0xffff0000, v45
  v_mul_f32 v45, v45, v42
  v_cvt_pk_bf16_f32 v45, v45, v45
  v_and_b32 v45, 0xffff0000, v45
  v_sub_f32 v46, v46, v40
  v_cvt_pk_bf16_f32 v46, v46, v46
  v_and_b32 v46, 0xffff0000, v46
  v_mul_f32 v46, v46, v42
  v_cvt_pk_bf16_f32 v46, v46, v46
  v_and_b32 v46, 0xffff0000, v46
  v_sub_f32 v47, v47, v40
  v_cvt_pk_bf16_f32 v47, v47, v47
  v_and_b32 v47, 0xffff0000, v47
  v_mul_f32 v47, v47, v42
  v_cvt_pk_bf16_f32 v47, v47, v47
  v_and_b32 v47, 0xffff0000, v47
  v_and_b32 v6, 3, v1
  v_lshrrev_b32 v7, 2, v1
  v_lshl_add_u32 v6, s56, 4, v6
  v_mul_u32_u24 v6, 48, v6
  v_lshl_add_u32 v48, v7, 2, v6
  v_add_u32 v48, 0, v48
  v_lshrrev_b32 v6, 3, v2
  v_lshl_add_u32 v6, v6, 2, v3
  v_lshlrev_b32 v6, 2, v6
  v_add_u32 v6, s3, v6
  v_mul_u32_u24 v49, 48, v6
  v_add_u32 v49, 0, v49
  v_lshrrev_b32 v6, 1, v3
  v_lshlrev_b32 v6, 9, v6
  v_lshl_add_u32 v6, v2, 5, v6
  v_and_b32 v7, 1, v3
  v_lshl_add_u32 v6, v7, 4, v6
  s_lshl_b32 s48, s3, 10
  s_add_u32 s48, s48, 4096
  v_add_u32 v50, s48, v6
  s_lshl_b32 s48, s3, 8
  v_lshlrev_b32 v51, 4, v1
  v_add_u32 v51, s48, v51
  s_waitcnt lgkmcnt(0)
  s_and_b32 s12, s12, 0xff
  s_add_u32 s12, s12, 1
  s_cmp_eq_u32 s12, 256
  s_cselect_b32 s12, 1, s12
  s_mul_i32 s13, s12, 0x01010101
  v_mov_b32 v4, s12
  s_cmp_ge_u32 s3, 2
  s_cbranch_scc1 L_skipA_1
  s_mov_b32 s48, 5120
  v_and_b32 v7, 7, v1
  v_lshlrev_b32 v7, 7, v7
L_db_2:
  buffer_load_dword v6, v7, s[8:11], s48 offen sc1
  s_waitcnt vmcnt(0)
  v_cmp_ne_u32 vcc, s13, v6
  s_nop 0
  s_cbranch_vccz L_dbd_3
  s_sleep 1
  s_add_u32 s15, s15, 1
  s_cmp_lt_u32 s15, 100000
  s_cbranch_scc1 L_db_2
L_dbd_3:
  v_cmp_gt_u32 vcc, 40, v1
  s_nop 0
  s_and_saveexec_b64 s[44:45], vcc
  v_lshlrev_b32 v8, 4, v1
  s_mul_i32 s60, s56, 5120
  s_mul_i32 s61, s20, 640
  s_add_u32 s60, s60, s61
  s_add_u32 s60, s60, 65536
  s_add_u32 s61, s60, 10240
  s_add_u32 s62, s61, 10240
  s_add_u32 s63, s62, 10240
  buffer_load_dwordx4 v[208:211], v8, s[8:11], s60 offen sc1
  buffer_load_dwordx4 v[212:215], v8, s[8:11], s60 offen offset:2560 sc1
  buffer_load_dwordx4 v[216:219], v8, s[8:11], s61 offen sc1
  buffer_load_dwordx4 v[220:223], v8, s[8:11], s61 offen offset:2560 sc1
  buffer_load_dwordx4 v[224:227], v8, s[8:11], s62 offen sc1
  buffer_load_dwordx4 v[228:231], v8, s[8:11], s62 offen offset:2560 sc1
  buffer_load_dwordx4 v[232:235], v8, s[8:11], s63 offen sc1
  buffer_load_dwordx4 v[236:239], v8, s[8:11], s63 offen offset:2560 sc1
  v_mov_b32 v9, 0
  s_waitcnt vmcnt(7)
  v_msad_u8 v9, v208, v4, v9
  v_msad_u8 v9, v209, v4, v9
  v_msad_u8 v9, v210, v4, v9
  v_msad_u8 v9, v211, v4, v9
  s_waitcnt vmcnt(6)
  v_msad_u8 v9, v212, v4, v9
  v_msad_u8 v9, v213, v4, v9
  v_msad_u8 v9, v214, v4, v9
  v_msad_u8 v9, v215, v4, v9
  s_waitcnt vmcnt(5)
  v_msad_u8 v9, v216, v4, v9
  v_msad_u8 v9, v217, v4, v9
  v_msad_u8 v9, v218, v4, v9
  v_msad_u8 v9, v219, v4, v9
  s_waitcnt vmcnt(4)
  v_msad_u8 v9, v220, v4, v9
  v_msad_u8 v9, v221, v4, v9
  v_msad_u8 v9, v222, v4, v9
  v_msad_u8 v9, v223, v4, v9
  s_waitcnt vmcnt(3)
  v_msad_u8 v9, v224, v4, v9
  v_msad_u8 v9, v225, v4, v9
  v_msad_u8 v9, v226, v4, v9
  v_msad_u8 v9, v227, v4, v9
  s_waitcnt vmcnt(2)
  v_msad_u8 v9, v228, v4, v9
  v_msad_u8 v9, v229, v4, v9
  v_msad_u8 v9, v230, v4, v9
  v_msad_u8 v9, v231, v4, v9
  s_waitcnt vmcnt(1)
  v_msad_u8 v9, v232, v4, v9
  v_msad_u8 v9, v233, v4, v9
  v_msad_u8 v9, v234, v4, v9
  v_msad_u8 v9, v235, v4, v9
  s_waitcnt vmcnt(0)
  v_msad_u8 v9, v236, v4, v9
  v_msad_u8 v9, v237, v4, v9
  v_msad_u8 v9, v238, v4, v9
  v_msad_u8 v9, v239, v4, v9
  v_cmp_ne_u32 vcc, 0, v9
  s_nop 0
  s_cbranch_vccz L_pld_4
L_pls_5:
  s_mov_b32 s100, 0
  v_mov_b32 v9, 0
  v_msad_u8 v9, v208, v4, v9
  v_msad_u8 v9, v209, v4, v9
  v_msad_u8 v9, v210, v4, v9
  v_msad_u8 v9, v211, v4, v9
  v_cmp_ne_u32 vcc, 0, v9
  s_nop 0
  s_cbranch_vccz L_plk_6
  buffer_load_dwordx4 v[208:211], v8, s[8:11], s60 offen sc1
  s_mov_b32 s100, 1
L_plk_6:
  v_mov_b32 v9, 0
  v_msad_u8 v9, v212, v4, v9
  v_msad_u8 v9, v213, v4, v9
  v_msad_u8 v9, v214, v4, v9
  v_msad_u8 v9, v215, v4, v9
  v_cmp_ne_u32 vcc, 0, v9
  s_nop 0
  s_cbranch_vccz L_plk_7
  buffer_load_dwordx4 v[212:215], v8, s[8:11], s60 offen offset:2560 sc1
  s_mov_b32 s100, 1
L_plk_7:
  v_mov_b32 v9, 0
  v_msad_u8 v9, v216, v4, v9
  v_msad_u8 v9, v217, v4, v9
  v_msad_u8 v9, v218, v4, v9
  v_msad_u8 v9, v219, v4, v9
  v_cmp_ne_u32 vcc, 0, v9
  s_nop 0
  s_cbranch_vccz L_plk_8
  buffer_load_dwordx4 v[216:219], v8, s[8:11], s61 offen sc1
  s_mov_b32 s100, 1
L_plk_8:
  v_mov_b32 v9, 0
  v_msad_u8 v9, v220, v4, v9
  v_msad_u8 v9, v221, v4, v9
  v_msad_u8 v9, v222, v4, v9
  v_msad_u8 v9, v223, v4, v9
  v_cmp_ne_u32 vcc, 0, v9
  s_nop 0
  s_cbranch_vccz L_plk_9
  buffer_load_dwordx4 v[220:223], v8, s[8:11], s61 offen offset:2560 sc1
  s_mov_b32 s100, 1
L_plk_9:
  v_mov_b32 v9, 0
  v_msad_u8 v9, v224, v4, v9
  v_msad_u8 v9, v225, v4, v9
  v_msad_u8 v9, v226, v4, v9
  v_msad_u8 v9, v227, v4, v9
  v_cmp_ne_u32 vcc, 0, v9
  s_nop 0
  s_cbranch_vccz L_plk_10
  buffer_load_dwordx4 v[224:227], v8, s[8:11], s62 offen sc1
  s_mov_b32 s100, 1
L_plk_10:
  v_mov_b32 v9, 0
  v_msad_u8 v9, v228, v4, v9
  v_msad_u8 v9, v229, v4, v9
  v_msad_u8 v9, v230, v4, v9
  v_msad_u8 v9, v231, v4, v9
  v_cmp_ne_u32 vcc, 0, v9
  s_nop 0
  s_cbranch_vccz L_plk_11
  buffer_load_dwordx4 v[228:231], v8, s[8:11], s62 offen offset:2560 sc1
  s_mov_b32 s100, 1
L_plk_11:
  v_mov_b32 v9, 0
  v_msad_u8 v9, v232, v4, v9
  v_msad_u8 v9, v233, v4, v9
  v_msad_u8 v9, v234, v4, v9
  v_msad_u8 v9, v235, v4, v9
  v_cmp_ne_u32 vcc, 0, v9
  s_nop 0
  s_cbranch_vccz L_plk_12
  buffer_load_dwordx4 v[232:235], v8, s[8:11], s63 offen sc1
  s_mov_b32 s100, 1
L_plk_12:
  v_mov_b32 v9, 0
  v_msad_u8 v9, v236, v4, v9
  v_msad_u8 v9, v237, v4, v9
  v_msad_u8 v9, v238, v4, v9
  v_msad_u8 v9, v239, v4, v9
  v_cmp_ne_u32 vcc, 0, v9
  s_nop 0
  s_cbranch_vccz L_plk_13
  buffer_load_dwordx4 v[236:239], v8, s[8:11], s63 offen offset:2560 sc1
  s_mov_b32 s100, 1
L_plk_13:
  s_cmp_eq_u32 s100, 0
  s_cbranch_scc1 L_pld_4
  s_waitcnt vmcnt(0)
  s_add_u32 s15, s15, 1
  s_cmp_lt_u32 s15, 100000
  s_cbranch_scc1 L_pls_5
L_pld_4:
  v_add_f32 v208, v208, v216
  v_add_f32 v224, v224, v232
  v_add_f32 v208, v208, v224
  v_add_f32 v209, v209, v217
  v_add_f32 v225, v225, v233
  v_add_f32 v209, v209, v225
  v_add_f32 v210, v210, v218
  v_add_f32 v226, v226, v234
  v_add_f32 v210, v210, v226
  v_add_f32 v211, v211, v219
  v_add_f32 v227, v227, v235
  v_add_f32 v211, v211, v227
  v_add_f32 v212, v212, v220
  v_add_f32 v228, v228, v236
  v_add_f32 v212, v212, v228
  v_add_f32 v213, v213, v221
  v_add_f32 v229, v229, v237
  v_add_f32 v213, v213, v229
  v_add_f32 v214, v214, v222
  v_add_f32 v230, v230, v238
  v_add_f32 v214, v214, v230
  v_add_f32 v215, v215, v223
  v_add_f32 v231, v231, v239
  v_add_f32 v215, v215, v231
  v_cvt_pk_bf16_f32 v208, v208, v208
  v_and_b32 v208, 0xffff0000, v208
  v_cvt_pk_bf16_f32 v209, v209, v209
  v_and_b32 v209, 0xffff0000, v209
  v_cvt_pk_bf16_f32 v210, v210, v210
  v_and_b32 v210, 0xffff0000, v210
  v_cvt_pk_bf16_f32 v211, v211, v211
  v_and_b32 v211, 0xffff0000, v211
  v_cvt_pk_bf16_f32 v212, v212, v212
  v_and_b32 v212, 0xffff0000, v212
  v_cvt_pk_bf16_f32 v213, v213, v213
  v_and_b32 v213, 0xffff0000, v213
  v_cvt_pk_bf16_f32 v214, v214, v214
  v_and_b32 v214, 0xffff0000, v214
  v_cvt_pk_bf16_f32 v215, v215, v215
  v_and_b32 v215, 0xffff0000, v215
  v_add_f32 v212, 1.0, v212
  v_cvt_pk_bf16_f32 v212, v212, v212
  v_and_b32 v212, 0xffff0000, v212
  v_mul_f32 v212, v44, v212
  v_cvt_pk_bf16_f32 v212, v212, v212
  v_and_b32 v212, 0xffff0000, v212
  v_add_f32 v212, v212, v208
  v_cvt_pk_bf16_f32 v212, v212, v212
  v_add_f32 v213, 1.0, v213
  v_cvt_pk_bf16_f32 v213, v213, v213
  v_and_b32 v213, 0xffff0000, v213
  v_mul_f32 v213, v45, v213
  v_cvt_pk_bf16_f32 v213, v213, v213
  v_and_b32 v213, 0xffff0000, v213
  v_add_f32 v213, v213, v209
  v_cvt_pk_bf16_f32 v213, v213, v213
  v_add_f32 v214, 1.0, v214
  v_cvt_pk_bf16_f32 v214, v214, v214
  v_and_b32 v214, 0xffff0000, v214
  v_mul_f32 v214, v46, v214
  v_cvt_pk_bf16_f32 v214, v214, v214
  v_and_b32 v214, 0xffff0000, v214
  v_add_f32 v214, v214, v210
  v_cvt_pk_bf16_f32 v214, v214, v214
  v_add_f32 v215, 1.0, v215
  v_cvt_pk_bf16_f32 v215, v215, v215
  v_and_b32 v215, 0xffff0000, v215
  v_mul_f32 v215, v47, v215
  v_cvt_pk_bf16_f32 v215, v215, v215
  v_and_b32 v215, 0xffff0000, v215
  v_add_f32 v215, v215, v211
  v_cvt_pk_bf16_f32 v215, v215, v215
  ds_write_b32 v48, v212 offset:0
  ds_write_b32 v48, v213 offset:192
  ds_write_b32 v48, v214 offset:384
  ds_write_b32 v48, v215 offset:576
  s_mov_b64 exec, s[44:45]
L_skipA_1:
  s_waitcnt lgkmcnt(0)
  s_barrier
  ds_read_b128 v[208:211], v49 offset:0
  ds_read_b128 v[212:215], v49 offset:16
  ds_read_b128 v[216:219], v49 offset:32
  s_waitcnt vmcnt(8) lgkmcnt(0)
  v_mov_b32 v232, 0
  v_mov_b32 v233, 0
  v_mov_b32 v234, 0
  v_mov_b32 v235, 0
  v_and_b32 v224, v208, v24
  v_and_b32 v225, v208, v25
  v_and_b32 v226, v208, v26
  v_and_b32 v227, v208, v27
  v_and_b32 v228, v209, v24
  v_and_b32 v229, v209, v25
  v_and_b32 v230, v209, v26
  v_and_b32 v231, v209, v27
  v_mfma_f32_16x16x32_bf16 v[232:235], v[224:227], v[64:67], v[232:235]
  v_and_b32 v224, v210, v24
  v_and_b32 v225, v210, v25
  v_and_b32 v226, v210, v26
  v_and_b32 v227, v210, v27
  v_mfma_f32_16x16x32_bf16 v[232:235], v[228:231], v[68:71], v[232:235]
  v_and_b32 v228, v211, v24
  v_and_b32 v229, v211, v25
  v_and_b32 v230, v211, v26
  v_and_b32 v231, v211, v27
  v_mfma_f32_16x16x32_bf16 v[232:235], v[224:227], v[72:75], v[232:235]
  v_and_b32 v224, v212, v24
  v_and_b32 v225, v212, v25
  v_and_b32 v226, v212, v26
  v_and_b32 v227, v212, v27
  v_mfma_f32_16x16x32_bf16 v[232:235], v[228:231], v[76:79], v[232:235]
  v_and_b32 v228, v213, v24
  v_and_b32 v229, v213, v25
  v_and_b32 v230, v213, v26
  v_and_b32 v231, v213, v27
  v_mfma_f32_16x16x32_bf16 v[232:235], v[224:227], v[80:83], v[232:235]
  v_and_b32 v224, v214, v24
  v_and_b32 v225, v214, v25
  v_and_b32 v226, v214, v26
  v_and_b32 v227, v214, v27
  v_mfma_f32_16x16x32_bf16 v[232:235], v[228:231], v[84:87], v[232:235]
  v_and_b32 v228, v215, v24
  v_and_b32 v229, v215, v25
  v_and_b32 v230, v215, v26
  v_and_b32 v231, v215, v27
  v_mfma_f32_16x16x32_bf16 v[232:235], v[224:227], v[88:91], v[232:235]
  v_and_b32 v224, v216, v24
  v_and_b32 v225, v216, v25
  v_and_b32 v226, v216, v26
  v_and_b32 v227, v216, v27
  v_mfma_f32_16x16x32_bf16 v[232:235], v[228:231], v[92:95], v[232:235]
  v_and_b32 v228, v217, v24
  v_and_b32 v229, v217, v25
  v_and_b32 v230, v217, v26
  v_and_b32 v231, v217, v27
  v_mfma_f32_16x16x32_bf16 v[232:235], v[224:227], v[96:99], v[232:235]
  s_nop 0
  v_mfma_f32_16x16x32_bf16 v[232:235], v[228:231], v[100:103], v[232:235]
  s_nop 7
  ds_write_b128 v50, v[232:235]
  s_waitcnt lgkmcnt(0)
  s_barrier
  v_lshlrev_b32 v7, 2, v0
  v_add_u32 v6, 4096, v7
  ds_read_b32 v208, v6 offset:0
  ds_read_b32 v209, v6 offset:1024
  ds_read_b32 v210, v6 offset:2048
  ds_read_b32 v211, v6 offset:3072
  s_lshl_b32 s60, s19, 12
  s_add_u32 s60, s60, 196608
  s_lshl_b32 s61, s20, 10
  s_add_u32 s61, s61, s60
  s_waitcnt lgkmcnt(0)
  v_add_f32 v208, v208, v209
  v_add_f32 v210, v210, v211
  v_add_f32 v208, v208, v210
  v_bfi_b32 v208, s14, v4, v208
  buffer_store_dword v208, v7, s[8:11], s61 offen sc1
  s_mov_b32 s101, 0x00010001
  v_mov_b32 v30, 0x07060302
  s_lshr_b32 s48, s12, 0
  s_and_b32 s49, s48, 1
  s_lshl_b32 s48, s48, 15
  s_and_b32 s48, s48, 0x10000
  s_xor_b32 s7, s48, 0x10000
  s_lshl_b32 s6, s49, 16
  s_xor_b32 s6, s6, 0x10000
  s_or_b32 s48, s48, s49
  v_mov_b32 v56, s48
  s_lshr_b32 s48, s12, 2
  s_and_b32 s49, s48, 1
  s_lshl_b32 s48, s48, 15
  s_and_b32 s48, s48, 0x10000
  s_xor_b32 s79, s48, 0x10000
  s_lshl_b32 s78, s49, 16
  s_xor_b32 s78, s78, 0x10000
  s_or_b32 s48, s48, s49
  v_mov_b32 v57, s48
  s_lshr_b32 s48, s12, 4
  s_and_b32 s49, s48, 1
  s_lshl_b32 s48, s48, 15
  s_and_b32 s48, s48, 0x10000
  s_xor_b32 s85, s48, 0x10000
  s_lshl_b32 s84, s49, 16
  s_xor_b32 s84, s84, 0x10000
  s_or_b32 s48, s48, s49
  v_mov_b32 v58, s48
  s_lshr_b32 s48, s12, 6
  s_and_b32 s49, s48, 1
  s_lshl_b32 s48, s48, 15
  s_and_b32 s48, s48, 0x10000
  s_xor_b32 s87, s48, 0x10000
  s_lshl_b32 s86, s49, 16
  s_xor_b32 s86, s86, 0x10000
  s_or_b32 s48, s48, s49
  v_mov_b32 v59, s48
  s_waitcnt vmcnt(0)
  v_lshlrev_b32 v6, 8, v2
  v_lshl_add_u32 v6, v3, 4, v6
  s_lshl_b32 s48, s3, 13
  s_add_u32 s48, s48, 32768
  v_add_u32 v6, s48, v6
  ds_read_b128 v[104:107], v6 offset:0
  ds_read_b128 v[108:111], v6 offset:64
  ds_read_b128 v[112:115], v6 offset:128
  ds_read_b128 v[116:119], v6 offset:192
  ds_read_b128 v[120:123], v6 offset:4096
  ds_read_b128 v[124:127], v6 offset:4160
  ds_read_b128 v[128:131], v6 offset:4224
  ds_read_b128 v[132:135], v6 offset:4288
  v_cmp_gt_u32 vcc, 16, v1
  s_nop 0
  s_and_saveexec_b64 s[44:45], vcc
  buffer_load_dwordx4 v[212:215], v51, s[8:11], s60 offen sc1
  buffer_load_dwordx4 v[216:219], v51, s[8:11], s60 offen offset:1024 sc1
  buffer_load_dwordx4 v[220:223], v51, s[8:11], s60 offen offset:2048 sc1
  buffer_load_dwordx4 v[224:227], v51, s[8:11], s60 offen offset:3072 sc1
  v_mov_b32 v9, 0
  s_waitcnt vmcnt(3)
  v_msad_u8 v9, v212, v4, v9
  v_msad_u8 v9, v213, v4, v9
  v_msad_u8 v9, v214, v4, v9
  v_msad_u8 v9, v215, v4, v9
  s_waitcnt vmcnt(2)
  v_msad_u8 v9, v216, v4, v9
  v_msad_u8 v9, v217, v4, v9
  v_msad_u8 v9, v218, v4, v9
  v_msad_u8 v9, v219, v4, v9
  s_waitcnt vmcnt(1)
  v_msad_u8 v9, v220, v4, v9
  v_msad_u8 v9, v221, v4, v9
  v_msad_u8 v9, v222, v4, v9
  v_msad_u8 v9, v223, v4, v9
  s_waitcnt vmcnt(0)
  v_msad_u8 v9, v224, v4, v9
  v_msad_u8 v9, v225, v4, v9
  v_msad_u8 v9, v226, v4, v9
  v_msad_u8 v9, v227, v4, v9
  v_cmp_ne_u32 vcc, 0, v9
  s_nop 0
  s_cbranch_vccz L_pld_14
L_pls_15:
  s_mov_b32 s100, 0
  v_mov_b32 v9, 0
  v_msad_u8 v9, v212, v4, v9
  v_msad_u8 v9, v213, v4, v9
  v_msad_u8 v9, v214, v4, v9
  v_msad_u8 v9, v215, v4, v9
  v_cmp_ne_u32 vcc, 0, v9
  s_nop 0
  s_cbranch_vccz L_plk_16
  buffer_load_dwordx4 v[212:215], v51, s[8:11], s60 offen sc1
  s_mov_b32 s100, 1
L_plk_16:
  v_mov_b32 v9, 0
  v_msad_u8 v9, v216, v4, v9
  v_msad_u8 v9, v217, v4, v9
  v_msad_u8 v9, v218, v4, v9
  v_msad_u8 v9, v219, v4, v9
  v_cmp_ne_u32 vcc, 0, v9
  s_nop 0
  s_cbranch_vccz L_plk_17
  buffer_load_dwordx4 v[216:219], v51, s[8:11], s60 offen offset:1024 sc1
  s_mov_b32 s100, 1
L_plk_17:
  v_mov_b32 v9, 0
  v_msad_u8 v9, v220, v4, v9
  v_msad_u8 v9, v221, v4, v9
  v_msad_u8 v9, v222, v4, v9
  v_msad_u8 v9, v223, v4, v9
  v_cmp_ne_u32 vcc, 0, v9
  s_nop 0
  s_cbranch_vccz L_plk_18
  buffer_load_dwordx4 v[220:223], v51, s[8:11], s60 offen offset:2048 sc1
  s_mov_b32 s100, 1
L_plk_18:
  v_mov_b32 v9, 0
  v_msad_u8 v9, v224, v4, v9
  v_msad_u8 v9, v225, v4, v9
  v_msad_u8 v9, v226, v4, v9
  v_msad_u8 v9, v227, v4, v9
  v_cmp_ne_u32 vcc, 0, v9
  s_nop 0
  s_cbranch_vccz L_plk_19
  buffer_load_dwordx4 v[224:227], v51, s[8:11], s60 offen offset:3072 sc1
  s_mov_b32 s100, 1
L_plk_19:
  s_cmp_eq_u32 s100, 0
  s_cbranch_scc1 L_pld_14
  s_waitcnt vmcnt(0)
  s_add_u32 s15, s15, 1
  s_cmp_lt_u32 s15, 100000
  s_cbranch_scc1 L_pls_15
L_pld_14:
  v_add_f32 v212, v212, v216
  v_add_f32 v220, v220, v224
  v_add_f32 v212, v212, v220
  v_add_f32 v213, v213, v217
  v_add_f32 v221, v221, v225
  v_add_f32 v213, v213, v221
  v_add_f32 v214, v214, v218
  v_add_f32 v222, v222, v226
  v_add_f32 v214, v214, v222
  v_add_f32 v215, v215, v219
  v_add_f32 v223, v223, v227
  v_add_f32 v215, v215, v223
  v_cvt_pk_bf16_f32 v212, v212, v213
  v_cvt_pk_bf16_f32 v213, v214, v215
  v_lshrrev_b32 v6, 1, v51
  v_add_u32 v6, 2048, v6
  ds_write_b64 v6, v[212:213]
  s_mov_b64 exec, s[44:45]
  s_waitcnt lgkmcnt(0)
  s_barrier
  s_cmp_ge_u32 s16, 8
  s_cbranch_scc1 L_nr_20
  s_cmp_lg_u32 s3, 0
  s_cbranch_scc1 L_nr_20
  v_mov_b32 v6, s13
  s_lshl_b32 s48, s17, 7
  s_add_u32 s48, s48, 7168
  s_mov_b64 s[44:45], exec
  s_mov_b64 exec, 1
  buffer_store_dword v6, v5, s[8:11], s48 offen sc1
  s_mov_b64 exec, s[44:45]
L_nr_20:
  v_and_b32 v6, 1, v2
  v_lshlrev_b32 v6, 8, v6
  v_lshl_add_u32 v6, v3, 4, v6
  v_add_u32 v6, 2048, v6
  ds_read_b128 v[208:211], v6 offset:0
  ds_read_b128 v[212:215], v6 offset:64
  ds_read_b128 v[216:219], v6 offset:128
  ds_read_b128 v[220:223], v6 offset:192
  v_mov_b32 v224, 0
  v_mov_b32 v225, 0
  v_mov_b32 v226, 0
  v_mov_b32 v227, 0
  v_mov_b32 v228, 0
  v_mov_b32 v229, 0
  v_mov_b32 v230, 0
  v_mov_b32 v231, 0
  s_waitcnt lgkmcnt(0)
  v_mfma_f32_16x16x32_bf16 v[224:227], v[104:107], v[208:211], v[224:227]
  v_mfma_f32_16x16x32_bf16 v[228:231], v[120:123], v[208:211], v[228:231]
  v_mfma_f32_16x16x32_bf16 v[224:227], v[108:111], v[212:215], v[224:227]
  v_mfma_f32_16x16x32_bf16 v[228:231], v[124:127], v[212:215], v[228:231]
  v_mfma_f32_16x16x32_bf16 v[224:227], v[112:115], v[216:219], v[224:227]
  v_mfma_f32_16x16x32_bf16 v[228:231], v[128:131], v[216:219], v[228:231]
  v_mfma_f32_16x16x32_bf16 v[224:227], v[116:119], v[220:223], v[224:227]
  v_mfma_f32_16x16x32_bf16 v[228:231], v[132:135], v[220:223], v[228:231]
  v_lshlrev_b32 v6, 8, v2
  v_lshl_add_u32 v6, v3, 3, v6
  s_lshl_b32 s48, s3, 6
  s_add_u32 s48, s48, 3072
  v_add_u32 v6, s48, v6
  v_and_b32 v7, 1, v3
  v_cmp_eq_u32 vcc, 0, v7
  v_mov_b32 v232, s84
  v_mov_b32 v236, s6
  v_mov_b32 v233, s85
  v_mov_b32 v237, s7
  v_mov_b32 v234, s86
  v_mov_b32 v238, s78
  v_mov_b32 v235, s87
  v_mov_b32 v239, s79
  v_cndmask_b32 v232, v232, v236, vcc
  v_cndmask_b32 v233, v233, v237, vcc
  v_cndmask_b32 v234, v234, v238, vcc
  v_cndmask_b32 v235, v235, v239, vcc
  v_add_u32 v224, v232, v224
  v_add_u32 v225, v233, v225
  v_add_u32 v226, v234, v226
  v_add_u32 v227, v235, v227
  v_perm_b32 v224, v225, v224, v30
  v_perm_b32 v225, v227, v226, v30
  v_add_u32 v228, v232, v228
  v_add_u32 v229, v233, v229
  v_add_u32 v230, v234, v230
  v_add_u32 v231, v235, v231
  v_perm_b32 v228, v229, v228, v30
  v_perm_b32 v229, v231, v230, v30
  v_cmp_gt_u32 vcc, 2, v2
  s_nop 0
  s_and_saveexec_b64 s[44:45], vcc
  ds_write_b64 v6, v[224:225]
  ds_write_b64 v6, v[228:229] offset:32
  s_mov_b64 exec, s[44:45]
  s_waitcnt lgkmcnt(0)
  s_barrier
  s_cmp_lg_u32 s3, 0
  s_cbranch_scc1 L_skq_21
  v_cmp_gt_u32 vcc, 32, v1
  s_nop 0
  s_and_saveexec_b64 s[44:45], vcc
  v_lshlrev_b32 v6, 4, v1
  v_add_u32 v7, 3072, v6
  ds_read_b128 v[224:227], v7
  v_lshrrev_b32 v7, 4, v1
  v_lshlrev_b32 v7, 15, v7
  v_and_b32 v6, 15, v1
  v_lshl_add_u32 v6, v6, 4, v7
  s_lshl_b32 s60, s19, 10
  s_lshl_b32 s61, s20, 8
  s_add_u32 s60, s60, s61
  s_add_u32 s60, s60, 393216
  s_waitcnt lgkmcnt(0)
  v_bfi_b32 v224, s101, v56, v224
  v_bfi_b32 v225, s101, v57, v225
  v_bfi_b32 v226, s101, v58, v226
  v_bfi_b32 v227, s101, v59, v227
  buffer_store_dwordx4 v[224:227], v6, s[8:11], s60 offen sc1
  s_mov_b64 exec, s[44:45]
L_skq_21:
  s_lshl_b32 s49, s20, 20
  s_add_u32 s49, s49, s50
  s_lshl_b32 s51, s3, 18
  s_add_u32 s49, s49, s51
  buffer_load_dwordx4 v[136:139], v12, s[36:39], s49 offen nt
  s_add_u32 s49, s49, 8192
  buffer_load_dwordx4 v[140:143], v12, s[36:39], s49 offen nt
  s_add_u32 s49, s49, 8192
  buffer_load_dwordx4 v[144:147], v12, s[36:39], s49 offen nt
  s_add_u32 s49, s49, 8192
  buffer_load_dwordx4 v[148:151], v12, s[36:39], s49 offen nt
  s_add_u32 s49, s49, 8192
  buffer_load_dwordx4 v[152:155], v12, s[36:39], s49 offen nt
  s_add_u32 s49, s49, 8192
  buffer_load_dwordx4 v[156:159], v12, s[36:39], s49 offen nt
  s_add_u32 s49, s49, 8192
  buffer_load_dwordx4 v[160:163], v12, s[36:39], s49 offen nt
  s_add_u32 s49, s49, 8192
  buffer_load_dwordx4 v[164:167], v12, s[36:39], s49 offen nt
  s_cmp_ge_u32 s16, 80
  s_cbranch_scc1 L_skipA2_22
  v_lshrrev_b32 v6, 3, v2
  v_lshl_add_u32 v6, v6, 2, v3
  s_mov_b32 s48, 7680
  v_mul_lo_u32 v6, v6, s48
  v_and_b32 v7, 7, v2
  v_lshl_add_u32 v13, v7, 4, v6
  s_mul_i32 s49, s22, 2457600
  s_mul_i32 s51, s3, 61440
  s_add_u32 s49, s49, s51
  s_lshl_b32 s51, s21, 7
  s_add_u32 s49, s49, s51
  s_add_u32 s49, s49, 2560
  buffer_load_dwordx4 v[168:171], v13, s[52:55], s49 offen nt
  s_add_u32 s49, s49, 245760
  buffer_load_dwordx4 v[172:175], v13, s[52:55], s49 offen nt
  s_add_u32 s49, s49, 245760
  buffer_load_dwordx4 v[176:179], v13, s[52:55], s49 offen nt
  s_add_u32 s49, s49, 245760
  buffer_load_dwordx4 v[180:183], v13, s[52:55], s49 offen nt
  s_add_u32 s49, s49, 245760
  buffer_load_dwordx4 v[184:187], v13, s[52:55], s49 offen nt
  s_add_u32 s49, s49, 245760
  buffer_load_dwordx4 v[188:191], v13, s[52:55], s49 offen nt
  s_add_u32 s49, s49, 245760
  buffer_load_dwordx4 v[192:195], v13, s[52:55], s49 offen nt
  s_add_u32 s49, s49, 245760
  buffer_load_dwordx4 v[196:199], v13, s[52:55], s49 offen nt
  s_add_u32 s49, s49, 245760
  buffer_load_dwordx4 v[200:203], v13, s[52:55], s49 offen nt
  s_add_u32 s49, s49, 245760
  buffer_load_dwordx4 v[204:207], v13, s[52:55], s49 offen nt
  s_and_b32 s57, s3, 1
  v_and_b32 v6, 3, v2
  v_and_b32 v7, 1, v6
  v_lshrrev_b32 v6, 1, v6
  v_cmp_eq_u32 vcc, 1, v7
  v_mov_b32 v8, 0xffff
  v_mov_b32 v9, 0xffff0000
  v_cndmask_b32 v7, v8, v9, vcc
  v_cmp_eq_u32 vcc, 0, v6
  s_nop 1
  v_cndmask_b32 v28, 0, v7, vcc
  v_cmp_eq_u32 vcc, 1, v6
  s_nop 1
  v_cndmask_b32 v29, 0, v7, vcc
  v_lshlrev_b32 v208, 16, v22
  v_and_b32 v209, 0xffff0000, v22
  v_lshlrev_b32 v210, 16, v23
  v_and_b32 v211, 0xffff0000, v23
  v_mul_f32 v212, 0xbfb8aa3b, v208
  v_mul_f32 v213, 0xbfb8aa3b, v209
  v_mul_f32 v214, 0xbfb8aa3b, v210
  v_mul_f32 v215, 0xbfb8aa3b, v211
  v_exp_f32 v212, v212
  v_exp_f32 v213, v213
  v_exp_f32 v214, v214
  v_exp_f32 v215, v215
  v_add_f32 v212, 1.0, v212
  v_add_f32 v213, 1.0, v213
  v_add_f32 v214, 1.0, v214
  v_add_f32 v215, 1.0, v215
  v_rcp_f32 v212, v212
  v_rcp_f32 v213, v213
  v_rcp_f32 v214, v214
  v_rcp_f32 v215, v215
  v_mul_f32 v208, v208, v212
  v_mul_f32 v209, v209, v213
  v_mul_f32 v210, v210, v214
  v_mul_f32 v211, v211, v215
  v_cvt_pk_bf16_f32 v208, v208, v208
  v_cvt_pk_bf16_f32 v209, v209, v209
  v_cvt_pk_bf16_f32 v210, v210, v210
  v_cvt_pk_bf16_f32 v211, v211, v211
  s_lshr_b32 s48, s3, 1
  s_lshl_b32 s48, s48, 6
  v_add_u32 v6, s48, v1
  v_and_b32 v7, 1, v6
  v_lshrrev_b32 v8, 1, v6
  v_and_b32 v9, 3, v8
  v_lshrrev_b32 v8, 2, v8
  v_lshl_add_u32 v7, s57, 1, v7
  v_lshlrev_b32 v7, 4, v7
  v_add_u32 v7, v7, v9
  v_mul_u32_u24 v7, 48, v7
  v_lshl_add_u32 v7, v8, 2, v7
  v_add_u32 v7, 12288, v7
  v_cmp_gt_u32 vcc, 80, v6
  s_nop 0
  s_and_saveexec_b64 s[44:45], vcc
  ds_write_b32 v7, v208 offset:0
  ds_write_b32 v7, v209 offset:192
  ds_write_b32 v7, v210 offset:384
  ds_write_b32 v7, v211 offset:576
  s_mov_b64 exec, s[44:45]
  s_waitcnt lgkmcnt(0)
  s_barrier
  v_lshrrev_b32 v6, 2, v2
  v_lshl_add_u32 v6, v6, 2, v3
  v_lshlrev_b32 v6, 2, v6
  v_add_u32 v6, s3, v6
  v_mul_u32_u24 v6, 48, v6
  v_add_u32 v6, 12288, v6
  ds_read_b128 v[208:211], v6 offset:0
  ds_read_b128 v[212:215], v6 offset:16
  ds_read_b128 v[216:219], v6 offset:32
  v_and_b32 v6, 1, v3
  v_lshrrev_b32 v7, 3, v2
  v_cmp_eq_u32 s[46:47], v6, v7
  v_and_b32 v6, 1, v3
  v_lshrrev_b32 v7, 1, v3
  v_lshl_add_u32 v6, v6, 1, v7
  v_lshlrev_b32 v6, 8, v6
  v_and_b32 v7, 7, v2
  v_lshl_add_u32 v6, v7, 5, v6
  s_lshl_b32 s48, s3, 10
  s_add_u32 s48, s48, 4096
  v_add_u32 v52, s48, v6
  s_waitcnt vmcnt(0) lgkmcnt(0)
  v_mov_b32 v232, 0
  v_mov_b32 v233, 0
  v_mov_b32 v234, 0
  v_mov_b32 v235, 0
  v_mov_b32 v236, 0
  v_mov_b32 v237, 0
  v_mov_b32 v238, 0
  v_mov_b32 v239, 0
  v_mov_b32 v220, 0
  v_mov_b32 v221, 0
  v_mov_b32 v222, 0
  v_mov_b32 v223, 0
  v_mov_b32 v224, 0
  v_mov_b32 v225, 0
  v_mov_b32 v226, 0
  v_mov_b32 v227, 0
  v_mov_b32 v228, 0
  v_mov_b32 v229, 0
  v_mov_b32 v230, 0
  v_mov_b32 v231, 0
  v_and_b32 v222, v208, v28
  v_and_b32 v223, v208, v29
  v_and_b32 v228, v209, v28
  v_and_b32 v229, v209, v29
  v_mfma_f32_16x16x32_bf16 v[232:235], v[222:225], v[168:171], v[232:235]
  v_mfma_f32_16x16x32_bf16 v[236:239], v[220:223], v[168:171], v[236:239]
  v_and_b32 v222, v210, v28
  v_and_b32 v223, v210, v29
  v_mfma_f32_16x16x32_bf16 v[232:235], v[228:231], v[172:175], v[232:235]
  v_mfma_f32_16x16x32_bf16 v[236:239], v[226:229], v[172:175], v[236:239]
  v_and_b32 v228, v211, v28
  v_and_b32 v229, v211, v29
  v_mfma_f32_16x16x32_bf16 v[232:235], v[222:225], v[176:179], v[232:235]
  v_mfma_f32_16x16x32_bf16 v[236:239], v[220:223], v[176:179], v[236:239]
  v_and_b32 v222, v212, v28
  v_and_b32 v223, v212, v29
  v_mfma_f32_16x16x32_bf16 v[232:235], v[228:231], v[180:183], v[232:235]
  v_mfma_f32_16x16x32_bf16 v[236:239], v[226:229], v[180:183], v[236:239]
  v_and_b32 v228, v213, v28
  v_and_b32 v229, v213, v29
  v_mfma_f32_16x16x32_bf16 v[232:235], v[222:225], v[184:187], v[232:235]
  v_mfma_f32_16x16x32_bf16 v[236:239], v[220:223], v[184:187], v[236:239]
  v_and_b32 v222, v214, v28
  v_and_b32 v223, v214, v29
  v_mfma_f32_16x16x32_bf16 v[232:235], v[228:231], v[188:191], v[232:235]
  v_mfma_f32_16x16x32_bf16 v[236:239], v[226:229], v[188:191], v[236:239]
  v_and_b32 v228, v215, v28
  v_and_b32 v229, v215, v29
  v_mfma_f32_16x16x32_bf16 v[232:235], v[222:225], v[192:195], v[232:235]
  v_mfma_f32_16x16x32_bf16 v[236:239], v[220:223], v[192:195], v[236:239]
  v_and_b32 v222, v216, v28
  v_and_b32 v223, v216, v29
  v_mfma_f32_16x16x32_bf16 v[232:235], v[228:231], v[196:199], v[232:235]
  v_mfma_f32_16x16x32_bf16 v[236:239], v[226:229], v[196:199], v[236:239]
  v_and_b32 v228, v217, v28
  v_and_b32 v229, v217, v29
  v_mfma_f32_16x16x32_bf16 v[232:235], v[222:225], v[200:203], v[232:235]
  v_mfma_f32_16x16x32_bf16 v[236:239], v[220:223], v[200:203], v[236:239]
  v_mfma_f32_16x16x32_bf16 v[232:235], v[228:231], v[204:207], v[232:235]
  v_mfma_f32_16x16x32_bf16 v[236:239], v[226:229], v[204:207], v[236:239]
  s_mov_b64 s[44:45], exec
  s_mov_b64 exec, s[46:47]
  s_nop 4
  ds_write_b128 v52, v[232:235]
  ds_write_b128 v52, v[236:239] offset:16
  s_mov_b64 exec, s[44:45]
  s_waitcnt lgkmcnt(0)
  s_barrier
  v_cmp_gt_u32 vcc, 32, v1
  s_nop 0
  s_and_saveexec_b64 s[44:45], vcc
  s_lshl_b32 s48, s3, 7
  s_add_u32 s48, s48, 4096
  v_lshlrev_b32 v7, 2, v1
  v_add_u32 v8, s48, v7
  ds_read_b32 v208, v8 offset:0
  ds_read_b32 v209, v8 offset:512
  ds_read_b32 v210, v8 offset:1024
  ds_read_b32 v211, v8 offset:1536
  ds_read_b32 v212, v8 offset:2048
  ds_read_b32 v213, v8 offset:2560
  ds_read_b32 v214, v8 offset:3072
  ds_read_b32 v215, v8 offset:3584
  s_waitcnt lgkmcnt(0)
  v_add_f32 v208, v208, v212
  v_add_f32 v209, v209, v213
  v_add_f32 v210, v210, v214
  v_add_f32 v211, v211, v215
  v_add_f32 v208, v208, v209
  v_add_f32 v210, v210, v211
  v_add_f32 v240, v208, v210
  v_bfi_b32 v240, s14, v4, v240
  s_lshr_b32 s48, s3, 1
  s_lshl_b32 s60, s22, 1
  s_add_u32 s60, s60, s48
  s_mul_i32 s60, s60, 10240
  s_lshl_b32 s61, s21, 8
  s_add_u32 s60, s60, s61
  s_and_b32 s48, s3, 1
  s_lshl_b32 s48, s48, 7
  s_add_u32 s60, s60, s48
  s_add_u32 s60, s60, 131072
  buffer_store_dword v240, v7, s[8:11], s60 offen sc1
  s_mov_b64 exec, s[44:45]
  s_waitcnt lgkmcnt(0)
  s_barrier
L_skipA2_22:
  s_lshr_b32 s56, s3, 1
  v_and_b32 v8, 31, v1
  v_lshlrev_b32 v8, 4, v8
  v_lshlrev_b32 v9, 8, v3
  v_lshl_add_u32 v9, v2, 4, v9
  s_lshl_b32 s60, s56, 7
  s_add_u32 s60, s60, s16
  s_lshl_b32 s60, s60, 9
  s_add_u32 s60, s60, 5242880
  s_lshl_b32 s61, s16, 1
  s_add_u32 s61, s61, s56
  s_lshl_b32 s61, s61, 13
  s_and_b32 s48, s3, 1
  s_lshl_b32 s62, s48, 12
  s_add_u32 s61, s61, s62
  s_add_u32 s61, s61, 1048576
  s_lshl_b32 s48, s48, 6
  v_lshrrev_b32 v7, 3, v2
  v_lshlrev_b32 v53, 7, v7
  v_lshl_add_u32 v53, v3, 2, v53
  v_add_u32 v53, s48, v53
  v_lshrrev_b32 v7, 2, v2
  v_lshlrev_b32 v7, 7, v7
  v_and_b32 v6, 3, v2
  v_lshl_add_u32 v7, v6, 4, v7
  v_lshl_add_u32 v7, v3, 6, v7
  s_lshl_b32 s48, s3, 9
  s_add_u32 s48, s48, 16384
  v_add_u32 v55, s48, v7
  s_mov_b32 s48, 8192
  v_and_b32 v7, 7, v1
  v_lshlrev_b32 v7, 7, v7
L_db_23:
  buffer_load_dword v6, v7, s[8:11], s48 offen sc1
  s_waitcnt vmcnt(0)
  v_cmp_ne_u32 vcc, s13, v6
  s_nop 0
  s_cbranch_vccz L_dbd_24
  s_sleep 1
  s_add_u32 s15, s15, 1
  s_cmp_lt_u32 s15, 100000
  s_cbranch_scc1 L_db_23
L_dbd_24:
  buffer_load_dwordx4 v[204:207], v8, s[8:11], s60 offen sc1
  v_mov_b32 v6, 0
  s_waitcnt vmcnt(0)
  v_msad_u8 v6, v204, v4, v6
  v_msad_u8 v6, v205, v4, v6
  v_msad_u8 v6, v206, v4, v6
  v_msad_u8 v6, v207, v4, v6
  v_cmp_ne_u32 vcc, 0, v6
  s_nop 0
  s_cbranch_vccz L_pld_25
L_pls_26:
  s_mov_b32 s100, 0
  v_mov_b32 v6, 0
  v_msad_u8 v6, v204, v4, v6
  v_msad_u8 v6, v205, v4, v6
  v_msad_u8 v6, v206, v4, v6
  v_msad_u8 v6, v207, v4, v6
  v_cmp_ne_u32 vcc, 0, v6
  s_nop 0
  s_cbranch_vccz L_plk_27
  buffer_load_dwordx4 v[204:207], v8, s[8:11], s60 offen sc1
  s_mov_b32 s100, 1
L_plk_27:
  s_cmp_eq_u32 s100, 0
  s_cbranch_scc1 L_pld_25
  s_waitcnt vmcnt(0)
  s_add_u32 s15, s15, 1
  s_cmp_lt_u32 s15, 100000
  s_cbranch_scc1 L_pls_26
L_pld_25:
  v_mov_b32 v240, v204
  s_nop 1
  v_max_f32_dpp v240, v240, v240 quad_perm:[1,0,3,2] row_mask:0xf bank_mask:0xf
  s_nop 1
  v_max_f32_dpp v240, v240, v240 quad_perm:[2,3,0,1] row_mask:0xf bank_mask:0xf
  s_nop 1
  v_max_f32_dpp v240, v240, v240 row_half_mirror row_mask:0xf bank_mask:0xf
  s_nop 1
  v_max_f32_dpp v240, v240, v240 row_mirror row_mask:0xf bank_mask:0xf
  v_mov_b32 v241, v240
  s_nop 1
  v_permlane16_swap_b32 v240, v241
  v_max_f32 v240, v240, v241
  v_mov_b32 v241, v240
  s_nop 1
  v_permlane32_swap_b32 v240, v241
  v_max_f32 v240, v240, v241
  v_sub_f32 v240, v204, v240
  v_mul_f32 v240, 0x3e0293ee, v240
  v_exp_f32 v240, v240
  s_nop 0
  v_mul_f32 v242, v240, v205
  s_nop 1
  v_add_f32_dpp v242, v242, v242 quad_perm:[1,0,3,2] row_mask:0xf bank_mask:0xf
  s_nop 1
  v_add_f32_dpp v242, v242, v242 quad_perm:[2,3,0,1] row_mask:0xf bank_mask:0xf
  s_nop 1
  v_add_f32_dpp v242, v242, v242 row_half_mirror row_mask:0xf bank_mask:0xf
  s_nop 1
  v_add_f32_dpp v242, v242, v242 row_mirror row_mask:0xf bank_mask:0xf
  v_mov_b32 v241, v242
  s_nop 1
  v_permlane16_swap_b32 v242, v241
  v_add_f32 v242, v242, v241
  v_mov_b32 v241, v242
  s_nop 1
  v_permlane32_swap_b32 v242, v241
  v_add_f32 v242, v242, v241
  v_mul_f32 v242, 0.5, v242
  v_rcp_f32 v242, v242
  s_nop 0
  v_mul_f32 v240, v240, v242
  v_cvt_pk_bf16_f32 v241, v240, v240
  v_and_b32 v242, 0xffff0000, v241
  v_sub_f32 v242, v240, v242
  v_cvt_pk_bf16_f32 v242, v242, v242
  v_cmp_gt_u32 vcc, 32, v1
  s_nop 1
  v_cndmask_b32 v240, v242, v241, vcc
  v_add_u32 v6, 0, v53
  ds_bpermute_b32 v244, v6, v240
  v_add_u32 v6, 16, v53
  ds_bpermute_b32 v245, v6, v240
  v_add_u32 v6, 32, v53
  ds_bpermute_b32 v246, v6, v240
  v_add_u32 v6, 48, v53
  ds_bpermute_b32 v247, v6, v240
  buffer_load_dwordx4 v[208:211], v9, s[8:11], s61 offen sc1
  buffer_load_dwordx4 v[212:215], v9, s[8:11], s61 offen offset:1024 sc1
  buffer_load_dwordx4 v[216:219], v9, s[8:11], s61 offen offset:2048 sc1
  buffer_load_dwordx4 v[220:223], v9, s[8:11], s61 offen offset:3072 sc1
  v_mov_b32 v6, 0
  s_waitcnt vmcnt(3)
  v_xor_b32 v248, v208, v56
  v_xor_b32 v249, v209, v57
  v_or3_b32 v6, v6, v248, v249
  v_xor_b32 v248, v210, v58
  v_xor_b32 v249, v211, v59
  v_or3_b32 v6, v6, v248, v249
  s_waitcnt vmcnt(2)
  v_xor_b32 v248, v212, v56
  v_xor_b32 v249, v213, v57
  v_or3_b32 v6, v6, v248, v249
  v_xor_b32 v248, v214, v58
  v_xor_b32 v249, v215, v59
  v_or3_b32 v6, v6, v248, v249
  s_waitcnt vmcnt(1)
  v_xor_b32 v248, v216, v56
  v_xor_b32 v249, v217, v57
  v_or3_b32 v6, v6, v248, v249
  v_xor_b32 v248, v218, v58
  v_xor_b32 v249, v219, v59
  v_or3_b32 v6, v6, v248, v249
  s_waitcnt vmcnt(0)
  v_xor_b32 v248, v220, v56
  v_xor_b32 v249, v221, v57
  v_or3_b32 v6, v6, v248, v249
  v_xor_b32 v248, v222, v58
  v_xor_b32 v249, v223, v59
  v_or3_b32 v6, v6, v248, v249
  v_and_b32 v6, s101, v6
  v_cmp_ne_u32 vcc, 0, v6
  s_nop 0
  s_cbranch_vccz L_pld_28
L_pls_29:
  s_mov_b32 s100, 0
  v_mov_b32 v6, 0
  v_xor_b32 v248, v208, v56
  v_xor_b32 v249, v209, v57
  v_or3_b32 v6, v6, v248, v249
  v_xor_b32 v248, v210, v58
  v_xor_b32 v249, v211, v59
  v_or3_b32 v6, v6, v248, v249
  v_and_b32 v6, s101, v6
  v_cmp_ne_u32 vcc, 0, v6
  s_nop 0
  s_cbranch_vccz L_plk_30
  buffer_load_dwordx4 v[208:211], v9, s[8:11], s61 offen sc1
  s_mov_b32 s100, 1
L_plk_30:
  v_mov_b32 v6, 0
  v_xor_b32 v248, v212, v56
  v_xor_b32 v249, v213, v57
  v_or3_b32 v6, v6, v248, v249
  v_xor_b32 v248, v214, v58
  v_xor_b32 v249, v215, v59
  v_or3_b32 v6, v6, v248, v249
  v_and_b32 v6, s101, v6
  v_cmp_ne_u32 vcc, 0, v6
  s_nop 0
  s_cbranch_vccz L_plk_31
  buffer_load_dwordx4 v[212:215], v9, s[8:11], s61 offen offset:1024 sc1
  s_mov_b32 s100, 1
L_plk_31:
  v_mov_b32 v6, 0
  v_xor_b32 v248, v216, v56
  v_xor_b32 v249, v217, v57
  v_or3_b32 v6, v6, v248, v249
  v_xor_b32 v248, v218, v58
  v_xor_b32 v249, v219, v59
  v_or3_b32 v6, v6, v248, v249
  v_and_b32 v6, s101, v6
  v_cmp_ne_u32 vcc, 0, v6
  s_nop 0
  s_cbranch_vccz L_plk_32
  buffer_load_dwordx4 v[216:219], v9, s[8:11], s61 offen offset:2048 sc1
  s_mov_b32 s100, 1
L_plk_32:
  v_mov_b32 v6, 0
  v_xor_b32 v248, v220, v56
  v_xor_b32 v249, v221, v57
  v_or3_b32 v6, v6, v248, v249
  v_xor_b32 v248, v222, v58
  v_xor_b32 v249, v223, v59
  v_or3_b32 v6, v6, v248, v249
  v_and_b32 v6, s101, v6
  v_cmp_ne_u32 vcc, 0, v6
  s_nop 0
  s_cbranch_vccz L_plk_33
  buffer_load_dwordx4 v[220:223], v9, s[8:11], s61 offen offset:3072 sc1
  s_mov_b32 s100, 1
L_plk_33:
  s_cmp_eq_u32 s100, 0
  s_cbranch_scc1 L_pld_28
  s_waitcnt vmcnt(0)
  s_add_u32 s15, s15, 1
  s_cmp_lt_u32 s15, 100000
  s_cbranch_scc1 L_pls_29
L_pld_28:
  s_waitcnt lgkmcnt(0)
  v_mov_b32 v200, 0
  v_mov_b32 v201, 0
  v_mov_b32 v202, 0
  v_mov_b32 v203, 0
  v_and_b32 v224, v244, v24
  v_and_b32 v225, v244, v25
  v_and_b32 v226, v244, v26
  v_and_b32 v227, v244, v27
  v_and_b32 v228, v245, v24
  v_and_b32 v229, v245, v25
  v_and_b32 v230, v245, v26
  v_and_b32 v231, v245, v27
  v_mfma_f32_16x16x32_bf16 v[200:203], v[224:227], v[208:211], v[200:203]
  v_and_b32 v224, v246, v24
  v_and_b32 v225, v246, v25
  v_and_b32 v226, v246, v26
  v_and_b32 v227, v246, v27
  v_mfma_f32_16x16x32_bf16 v[200:203], v[228:231], v[212:215], v[200:203]
  v_and_b32 v228, v247, v24
  v_and_b32 v229, v247, v25
  v_and_b32 v230, v247, v26
  v_and_b32 v231, v247, v27
  v_mfma_f32_16x16x32_bf16 v[200:203], v[224:227], v[216:219], v[200:203]
  s_nop 0
  v_mfma_f32_16x16x32_bf16 v[200:203], v[228:231], v[220:223], v[200:203]
  s_nop 7
  v_mov_b32 v232, v200
  v_mov_b32 v233, v201
  v_mov_b32 v234, v202
  v_mov_b32 v235, v203
  v_permlane32_swap_b32 v200, v232
  v_permlane32_swap_b32 v201, v233
  v_permlane32_swap_b32 v202, v234
  v_permlane32_swap_b32 v203, v235
  v_add_f32 v200, v200, v232
  v_add_f32 v201, v201, v233
  v_add_f32 v202, v202, v234
  v_add_f32 v203, v203, v235
  v_cmp_gt_u32 vcc, 32, v1
  s_nop 0
  s_and_saveexec_b64 s[44:45], vcc
  ds_write_b128 v55, v[200:203]
  s_mov_b64 exec, s[44:45]
  v_lshrrev_b32 v6, 3, v2
  v_lshlrev_b32 v6, 10, v6
  v_lshl_add_u32 v6, v3, 5, v6
  s_lshl_b32 s48, s3, 7
  s_add_u32 s48, s48, 16384
  v_add_u32 v6, s48, v6
  s_waitcnt lgkmcnt(0)
  s_barrier
  s_cmp_ge_u32 s16, 8
  s_cbranch_scc1 L_nr_34
  s_cmp_lg_u32 s3, 0
  s_cbranch_scc1 L_nr_34
  v_mov_b32 v9, s13
  s_lshl_b32 s48, s17, 7
  s_add_u32 s48, s48, 9216
  s_mov_b64 s[44:45], exec
  s_mov_b64 exec, 1
  buffer_store_dword v9, v5, s[8:11], s48 offen sc1
  s_mov_b64 exec, s[44:45]
L_nr_34:
  ds_read_b128 v[208:211], v6
  ds_read_b128 v[212:215], v6 offset:16
  ds_read_b128 v[216:219], v6 offset:512
  ds_read_b128 v[220:223], v6 offset:528
  s_waitcnt lgkmcnt(0)
  v_add_f32 v208, v208, v216
  v_add_f32 v209, v209, v217
  v_add_f32 v210, v210, v218
  v_add_f32 v211, v211, v219
  v_add_f32 v212, v212, v220
  v_add_f32 v213, v213, v221
  v_add_f32 v214, v214, v222
  v_add_f32 v215, v215, v223
  v_cvt_pk_bf16_f32 v208, v208, v208
  v_cvt_pk_bf16_f32 v209, v209, v209
  v_cvt_pk_bf16_f32 v210, v210, v210
  v_cvt_pk_bf16_f32 v211, v211, v211
  v_cvt_pk_bf16_f32 v212, v212, v212
  v_cvt_pk_bf16_f32 v213, v213, v213
  v_cvt_pk_bf16_f32 v214, v214, v214
  v_cvt_pk_bf16_f32 v215, v215, v215
  v_mov_b32 v232, 0
  v_mov_b32 v233, 0
  v_mov_b32 v234, 0
  v_mov_b32 v235, 0
  v_and_b32 v224, v208, v24
  v_and_b32 v225, v208, v25
  v_and_b32 v226, v208, v26
  v_and_b32 v227, v208, v27
  v_and_b32 v228, v209, v24
  v_and_b32 v229, v209, v25
  v_and_b32 v230, v209, v26
  v_and_b32 v231, v209, v27
  v_mfma_f32_16x16x32_bf16 v[232:235], v[224:227], v[136:139], v[232:235]
  v_and_b32 v224, v210, v24
  v_and_b32 v225, v210, v25
  v_and_b32 v226, v210, v26
  v_and_b32 v227, v210, v27
  v_mfma_f32_16x16x32_bf16 v[232:235], v[228:231], v[140:143], v[232:235]
  v_and_b32 v228, v211, v24
  v_and_b32 v229, v211, v25
  v_and_b32 v230, v211, v26
  v_and_b32 v231, v211, v27
  v_mfma_f32_16x16x32_bf16 v[232:235], v[224:227], v[144:147], v[232:235]
  v_and_b32 v224, v212, v24
  v_and_b32 v225, v212, v25
  v_and_b32 v226, v212, v26
  v_and_b32 v227, v212, v27
  v_mfma_f32_16x16x32_bf16 v[232:235], v[228:231], v[148:151], v[232:235]
  v_and_b32 v228, v213, v24
  v_and_b32 v229, v213, v25
  v_and_b32 v230, v213, v26
  v_and_b32 v231, v213, v27
  v_mfma_f32_16x16x32_bf16 v[232:235], v[224:227], v[152:155], v[232:235]
  v_and_b32 v224, v214, v24
  v_and_b32 v225, v214, v25
  v_and_b32 v226, v214, v26
  v_and_b32 v227, v214, v27
  v_mfma_f32_16x16x32_bf16 v[232:235], v[228:231], v[156:159], v[232:235]
  v_and_b32 v228, v215, v24
  v_and_b32 v229, v215, v25
  v_and_b32 v230, v215, v26
  v_and_b32 v231, v215, v27
  v_mfma_f32_16x16x32_bf16 v[232:235], v[224:227], v[160:163], v[232:235]
  s_nop 0
  v_mfma_f32_16x16x32_bf16 v[232:235], v[228:231], v[164:167], v[232:235]
  s_nop 7
  ds_write_b128 v50, v[232:235]
  s_waitcnt lgkmcnt(0)
  s_barrier
  v_lshlrev_b32 v7, 2, v0
  v_add_u32 v6, 4096, v7
  ds_read_b32 v208, v6 offset:0
  ds_read_b32 v209, v6 offset:1024
  ds_read_b32 v210, v6 offset:2048
  ds_read_b32 v211, v6 offset:3072
  s_lshl_b32 s60, s19, 12
  s_lshl_b32 s61, s56, 11
  s_add_u32 s60, s60, s61
  s_lshl_b32 s61, s20, 9
  s_add_u32 s60, s60, s61
  s_and_b32 s61, s3, 1
  s_lshl_b32 s61, s61, 8
  s_add_u32 s60, s60, s61
  s_add_u32 s60, s60, 655360
  v_lshlrev_b32 v7, 2, v1
  s_waitcnt lgkmcnt(0)
  v_add_f32 v208, v208, v209
  v_add_f32 v210, v210, v211
  v_add_f32 v208, v208, v210
  v_bfi_b32 v208, s14, v4, v208
  buffer_store_dword v208, v7, s[8:11], s60 offen sc1
  s_endpgm
L_DG:
  s_lshr_b32 s18, s16, 3
  s_load_dwordx2 s[24:25], s[0:1], 8
  s_mov_b32 s26, 8388608
  s_mov_b32 s27, 0x20000
  s_load_dwordx2 s[28:29], s[0:1], 80
  s_mov_b32 s30, 2560
  s_mov_b32 s31, 0x20000
  s_load_dwordx2 s[32:33], s[0:1], 88
  s_mov_b32 s34, 4915200
  s_mov_b32 s35, 0x20000
  s_load_dwordx2 s[36:37], s[0:1], 40
  s_mov_b32 s38, 5242880
  s_mov_b32 s39, 0x20000
  s_load_dwordx2 s[40:41], s[0:1], 0
  s_mov_b32 s42, 2560
  s_mov_b32 s43, 0x20000
  s_load_dwordx2 s[52:53], s[0:1], 72
  s_mov_b32 s54, 2211840
  s_mov_b32 s55, 0x20000
  s_load_dwordx2 s[64:65], s[0:1], 96
  s_mov_b32 s66, 2560
  s_mov_b32 s67, 0x20000
  s_load_dwordx4 s[68:71], s[0:1], 56
  s_lshr_b32 s21, s16, 3
  s_and_b32 s21, s21, 1
  s_lshr_b32 s48, s16, 4
  s_lshl_b32 s48, s48, 3
  s_or_b32 s48, s48, s17
  s_lshr_b32 s19, s48, 5
  s_and_b32 s20, s48, 31
  s_mov_b32 s22, 0
  s_cmp_lt_u32 s18, 10
  s_cbranch_scc1 L_ROLE_DONE
  s_sub_u32 s23, s18, 10
  s_lshl_b32 s23, s23, 3
  s_add_u32 s23, s23, s17
  s_mov_b32 s22, 1
  s_cmp_lt_u32 s23, 27
  s_cbranch_scc1 L_ROLE_DONE
  s_mov_b32 s22, 2
  s_cmp_eq_u32 s18, 13
  s_cbranch_scc1 L_ROLE_13
  s_lshl_b32 s23, s17, 1
  s_add_u32 s23, s23, s18
  s_sub_u32 s23, s23, 14
  s_branch L_ROLE_DONE
L_ROLE_13:
  s_add_u32 s23, s17, 13
  s_cmp_lt_u32 s17, 7
  s_cbranch_scc1 L_ROLE_DONE
  s_mov_b32 s22, 3
L_ROLE_DONE:
  v_lshlrev_b32 v10, 4, v1
  s_lshl_b32 s72, s19, 12
  s_lshl_b32 s48, s20, 7
  s_add_u32 s72, s72, s48
  s_lshl_b32 s48, s3, 5
  s_add_u32 s72, s72, s48
  s_lshl_b32 s72, s72, 10
  s_mul_i32 s73, s3, 33792
  s_waitcnt lgkmcnt(0)
  s_cmp_lg_u32 s22, 0
  s_cbranch_scc1 L_notF_35
  s_and_b32 s74, s17, 1
  s_mul_i32 s74, s74, 10
  s_add_u32 s74, s74, s18
  s_lshr_b32 s75, s17, 1
  s_and_b32 s56, s3, 1
  s_mul_i32 s57, s56, 1280
  s_mul_i32 s48, s75, 320
  s_add_u32 s57, s57, s48
  v_lshlrev_b32 v7, 3, v1
  buffer_load_dwordx2 v[22:23], v7, s[28:31], s57 offen
  v_lshrrev_b32 v6, 3, v2
  v_lshl_add_u32 v6, v6, 2, v3
  s_mov_b32 s48, 7680
  v_mul_lo_u32 v6, v6, s48
  v_and_b32 v7, 7, v2
  v_lshl_add_u32 v11, v7, 4, v6
  s_mul_i32 s49, s75, 1228800
  s_mul_i32 s51, s3, 61440
  s_add_u32 s49, s49, s51
  s_lshl_b32 s51, s74, 7
  s_add_u32 s49, s49, s51
  buffer_load_dwordx4 v[32:35], v11, s[32:35], s49 offen nt
  s_add_u32 s49, s49, 245760
  buffer_load_dwordx4 v[36:39], v11, s[32:35], s49 offen nt
  s_add_u32 s49, s49, 245760
  buffer_load_dwordx4 v[40:43], v11, s[32:35], s49 offen nt
  s_add_u32 s49, s49, 245760
  buffer_load_dwordx4 v[44:47], v11, s[32:35], s49 offen nt
  s_add_u32 s49, s49, 245760
  buffer_load_dwordx4 v[48:51], v11, s[32:35], s49 offen nt
  s_mov_b32 m0, s73
  s_add_u32 s73, s73, 1056
  buffer_load_dwordx4 v10, s[24:27], s72 offen nt lds
  s_add_u32 s72, s72, 1024
  s_mov_b32 m0, s73
  s_add_u32 s73, s73, 1056
  buffer_load_dwordx4 v10, s[24:27], s72 offen nt lds
  s_add_u32 s72, s72, 1024
  s_mov_b32 m0, s73
  s_add_u32 s73, s73, 1056
  buffer_load_dwordx4 v10, s[24:27], s72 offen nt lds
  s_add_u32 s72, s72, 1024
  s_mov_b32 m0, s73
  s_add_u32 s73, s73, 1056
  buffer_load_dwordx4 v10, s[24:27], s72 offen nt lds
  s_add_u32 s72, s72, 1024
  s_load_dword s12, s[8:9], 0
  v_and_b32 v6, 3, v2
  v_and_b32 v7, 1, v6
  v_lshrrev_b32 v6, 1, v6
  v_cmp_eq_u32 vcc, 1, v7
  v_mov_b32 v8, 0xffff
  v_mov_b32 v9, 0xffff0000
  v_cndmask_b32 v7, v8, v9, vcc
  v_cmp_eq_u32 vcc, 0, v6
  s_nop 1
  v_cndmask_b32 v28, 0, v7, vcc
  v_cmp_eq_u32 vcc, 1, v6
  s_nop 1
  v_cndmask_b32 v29, 0, v7, vcc
  s_waitcnt vmcnt(9)
  v_lshlrev_b32 v116, 16, v22
  v_and_b32 v117, 0xffff0000, v22
  v_lshlrev_b32 v118, 16, v23
  v_and_b32 v119, 0xffff0000, v23
  v_mul_f32 v120, 0xbfb8aa3b, v116
  v_mul_f32 v121, 0xbfb8aa3b, v117
  v_mul_f32 v122, 0xbfb8aa3b, v118
  v_mul_f32 v123, 0xbfb8aa3b, v119
  v_exp_f32 v120, v120
  v_exp_f32 v121, v121
  v_exp_f32 v122, v122
  v_exp_f32 v123, v123
  v_add_f32 v120, 1.0, v120
  v_add_f32 v121, 1.0, v121
  v_add_f32 v122, 1.0, v122
  v_add_f32 v123, 1.0, v123
  v_rcp_f32 v120, v120
  v_rcp_f32 v121, v121
  v_rcp_f32 v122, v122
  v_rcp_f32 v123, v123
  v_mul_f32 v116, v116, v120
  v_mul_f32 v117, v117, v121
  v_mul_f32 v118, v118, v122
  v_mul_f32 v119, v119, v123
  v_cvt_pk_bf16_f32 v116, v116, v116
  v_cvt_pk_bf16_f32 v117, v117, v117
  v_cvt_pk_bf16_f32 v118, v118, v118
  v_cvt_pk_bf16_f32 v119, v119, v119
  v_and_b32 v7, 1, v1
  v_lshrrev_b32 v8, 1, v1
  v_and_b32 v9, 3, v8
  v_lshrrev_b32 v8, 2, v8
  v_lshl_add_u32 v7, s56, 1, v7
  v_lshlrev_b32 v7, 4, v7
  v_add_u32 v7, v7, v9
  v_lshlrev_b32 v7, 5, v7
  v_lshl_add_u32 v7, v8, 2, v7
  v_add_u32 v7, 158208, v7
  s_cmp_ge_u32 s3, 2
  s_cbranch_scc1 L_sk_36
  v_cmp_gt_u32 vcc, 40, v1
  s_nop 0
  s_and_saveexec_b64 s[44:45], vcc
  ds_write_b32 v7, v116 offset:0
  ds_write_b32 v7, v117 offset:128
  ds_write_b32 v7, v118 offset:256
  ds_write_b32 v7, v119 offset:384
  s_mov_b64 exec, s[44:45]
L_sk_36:
  v_lshrrev_b32 v6, 2, v2
  v_lshl_add_u32 v6, v6, 2, v3
  v_lshlrev_b32 v6, 2, v6
  v_add_u32 v6, s3, v6
  v_lshlrev_b32 v12, 5, v6
  v_add_u32 v12, 158208, v12
  v_and_b32 v6, 1, v3
  v_lshrrev_b32 v7, 3, v2
  v_cmp_eq_u32 s[46:47], v6, v7
  v_and_b32 v6, 1, v3
  v_lshrrev_b32 v7, 1, v3
  v_lshl_add_u32 v6, v6, 1, v7
  v_lshlrev_b32 v6, 8, v6
  v_and_b32 v7, 7, v2
  v_lshl_add_u32 v6, v7, 5, v6
  s_lshl_b32 s48, s3, 10
  s_add_u32 s48, s48, 135168
  v_add_u32 v13, s48, v6
  s_waitcnt lgkmcnt(0)
  s_barrier
  s_and_b32 s12, s12, 0xff
  s_add_u32 s12, s12, 1
  s_cmp_eq_u32 s12, 256
  s_cselect_b32 s12, 1, s12
  s_mul_i32 s13, s12, 0x01010101
  v_mov_b32 v4, s12
  ds_read_b128 v[116:119], v12 offset:0
  ds_read_b128 v[120:123], v12 offset:16
  s_waitcnt vmcnt(4) lgkmcnt(0)
  v_mov_b32 v72, 0
  v_mov_b32 v73, 0
  v_mov_b32 v74, 0
  v_mov_b32 v75, 0
  v_mov_b32 v76, 0
  v_mov_b32 v77, 0
  v_mov_b32 v78, 0
  v_mov_b32 v79, 0
  v_mov_b32 v60, 0
  v_mov_b32 v61, 0
  v_mov_b32 v62, 0
  v_mov_b32 v63, 0
  v_mov_b32 v64, 0
  v_mov_b32 v65, 0
  v_mov_b32 v66, 0
  v_mov_b32 v67, 0
  v_mov_b32 v68, 0
  v_mov_b32 v69, 0
  v_mov_b32 v70, 0
  v_mov_b32 v71, 0
  v_and_b32 v62, v116, v28
  v_and_b32 v63, v116, v29
  v_and_b32 v68, v117, v28
  v_and_b32 v69, v117, v29
  v_mfma_f32_16x16x32_bf16 v[72:75], v[62:65], v[32:35], v[72:75]
  v_mfma_f32_16x16x32_bf16 v[76:79], v[60:63], v[32:35], v[76:79]
  v_and_b32 v62, v118, v28
  v_and_b32 v63, v118, v29
  v_mfma_f32_16x16x32_bf16 v[72:75], v[68:71], v[36:39], v[72:75]
  v_mfma_f32_16x16x32_bf16 v[76:79], v[66:69], v[36:39], v[76:79]
  v_and_b32 v68, v119, v28
  v_and_b32 v69, v119, v29
  v_mfma_f32_16x16x32_bf16 v[72:75], v[62:65], v[40:43], v[72:75]
  v_mfma_f32_16x16x32_bf16 v[76:79], v[60:63], v[40:43], v[76:79]
  v_and_b32 v62, v120, v28
  v_and_b32 v63, v120, v29
  v_mfma_f32_16x16x32_bf16 v[72:75], v[68:71], v[44:47], v[72:75]
  v_mfma_f32_16x16x32_bf16 v[76:79], v[66:69], v[44:47], v[76:79]
  v_mfma_f32_16x16x32_bf16 v[72:75], v[62:65], v[48:51], v[72:75]
  v_mfma_f32_16x16x32_bf16 v[76:79], v[60:63], v[48:51], v[76:79]
  s_mov_b64 s[44:45], exec
  s_mov_b64 exec, s[46:47]
  s_nop 4
  ds_write_b128 v13, v[72:75]
  ds_write_b128 v13, v[76:79] offset:16
  s_mov_b64 exec, s[44:45]
  s_waitcnt lgkmcnt(0)
  s_barrier
  v_cmp_gt_u32 vcc, 32, v1
  s_nop 0
  s_and_saveexec_b64 s[44:45], vcc
  s_lshl_b32 s48, s3, 7
  s_add_u32 s48, s48, 135168
  v_lshlrev_b32 v7, 2, v1
  v_add_u32 v8, s48, v7
  ds_read_b32 v80, v8 offset:0
  ds_read_b32 v81, v8 offset:512
  ds_read_b32 v82, v8 offset:1024
  ds_read_b32 v83, v8 offset:1536
  ds_read_b32 v84, v8 offset:2048
  ds_read_b32 v85, v8 offset:2560
  ds_read_b32 v86, v8 offset:3072
  ds_read_b32 v87, v8 offset:3584
  s_waitcnt lgkmcnt(0)
  v_add_f32 v80, v80, v84
  v_add_f32 v81, v81, v85
  v_add_f32 v82, v82, v86
  v_add_f32 v83, v83, v87
  v_add_f32 v80, v80, v81
  v_add_f32 v82, v82, v83
  v_add_f32 v112, v80, v82
  v_bfi_b32 v112, s14, v4, v112
  s_lshr_b32 s48, s3, 1
  s_lshl_b32 s60, s75, 1
  s_add_u32 s60, s60, s48
  s_mul_i32 s60, s60, 5120
  s_lshl_b32 s61, s74, 8
  s_add_u32 s60, s60, s61
  s_and_b32 s48, s3, 1
  s_lshl_b32 s48, s48, 7
  s_add_u32 s60, s60, s48
  s_add_u32 s60, s60, 65536
  buffer_store_dword v112, v7, s[8:11], s60 offen sc1
  s_mov_b64 exec, s[44:45]
  s_cmp_ge_u32 s16, 8
  s_cbranch_scc1 L_nr_37
  s_cmp_lg_u32 s3, 0
  s_cbranch_scc1 L_nr_37
  v_mov_b32 v6, s13
  s_lshl_b32 s48, s17, 7
  s_add_u32 s48, s48, 5120
  s_mov_b64 s[44:45], exec
  s_mov_b64 exec, 1
  buffer_store_dword v6, v5, s[8:11], s48 offen sc1
  s_mov_b64 exec, s[44:45]
L_nr_37:
  s_mov_b32 m0, s73
  s_add_u32 s73, s73, 1056
  buffer_load_dwordx4 v10, s[24:27], s72 offen nt lds
  s_add_u32 s72, s72, 1024
  s_mov_b32 m0, s73
  s_add_u32 s73, s73, 1056
  buffer_load_dwordx4 v10, s[24:27], s72 offen nt lds
  s_add_u32 s72, s72, 1024
  s_mov_b32 m0, s73
  s_add_u32 s73, s73, 1056
  buffer_load_dwordx4 v10, s[24:27], s72 offen nt lds
  s_add_u32 s72, s72, 1024
  s_mov_b32 m0, s73
  s_add_u32 s73, s73, 1056
  buffer_load_dwordx4 v10, s[24:27], s72 offen nt lds
  s_add_u32 s72, s72, 1024
  s_mov_b32 m0, s73
  s_add_u32 s73, s73, 1056
  buffer_load_dwordx4 v10, s[24:27], s72 offen nt lds
  s_add_u32 s72, s72, 1024
  s_mov_b32 m0, s73
  s_add_u32 s73, s73, 1056
  buffer_load_dwordx4 v10, s[24:27], s72 offen nt lds
  s_add_u32 s72, s72, 1024
  s_mov_b32 m0, s73
  s_add_u32 s73, s73, 1056
  buffer_load_dwordx4 v10, s[24:27], s72 offen nt lds
  s_add_u32 s72, s72, 1024
  s_mov_b32 m0, s73
  s_add_u32 s73, s73, 1056
  buffer_load_dwordx4 v10, s[24:27], s72 offen nt lds
  s_add_u32 s72, s72, 1024
  s_mov_b32 m0, s73
  s_add_u32 s73, s73, 1056
  buffer_load_dwordx4 v10, s[24:27], s72 offen nt lds
  s_add_u32 s72, s72, 1024
  s_mov_b32 m0, s73
  s_add_u32 s73, s73, 1056
  buffer_load_dwordx4 v10, s[24:27], s72 offen nt lds
  s_add_u32 s72, s72, 1024
  s_mov_b32 m0, s73
  s_add_u32 s73, s73, 1056
  buffer_load_dwordx4 v10, s[24:27], s72 offen nt lds
  s_add_u32 s72, s72, 1024
  s_mov_b32 m0, s73
  s_add_u32 s73, s73, 1056
  buffer_load_dwordx4 v10, s[24:27], s72 offen nt lds
  s_add_u32 s72, s72, 1024
  s_mov_b32 m0, s73
  s_add_u32 s73, s73, 1056
  buffer_load_dwordx4 v10, s[24:27], s72 offen nt lds
  s_add_u32 s72, s72, 1024
  s_mov_b32 m0, s73
  s_add_u32 s73, s73, 1056
  buffer_load_dwordx4 v10, s[24:27], s72 offen nt lds
  s_add_u32 s72, s72, 1024
  s_mov_b32 m0, s73
  s_add_u32 s73, s73, 1056
  buffer_load_dwordx4 v10, s[24:27], s72 offen nt lds
  s_add_u32 s72, s72, 1024
  s_mov_b32 m0, s73
  s_add_u32 s73, s73, 1056
  buffer_load_dwordx4 v10, s[24:27], s72 offen nt lds
  s_add_u32 s72, s72, 1024
  s_mov_b32 m0, s73
  s_add_u32 s73, s73, 1056
  buffer_load_dwordx4 v10, s[24:27], s72 offen nt lds
  s_add_u32 s72, s72, 1024
  s_mov_b32 m0, s73
  s_add_u32 s73, s73, 1056
  buffer_load_dwordx4 v10, s[24:27], s72 offen nt lds
  s_add_u32 s72, s72, 1024
  s_mov_b32 m0, s73
  s_add_u32 s73, s73, 1056
  buffer_load_dwordx4 v10, s[24:27], s72 offen nt lds
  s_add_u32 s72, s72, 1024
  s_mov_b32 m0, s73
  s_add_u32 s73, s73, 1056
  buffer_load_dwordx4 v10, s[24:27], s72 offen nt lds
  s_add_u32 s72, s72, 1024
  s_mov_b32 m0, s73
  s_add_u32 s73, s73, 1056
  buffer_load_dwordx4 v10, s[24:27], s72 offen nt lds
  s_add_u32 s72, s72, 1024
  s_mov_b32 m0, s73
  s_add_u32 s73, s73, 1056
  buffer_load_dwordx4 v10, s[24:27], s72 offen nt lds
  s_add_u32 s72, s72, 1024
  s_mov_b32 m0, s73
  s_add_u32 s73, s73, 1056
  buffer_load_dwordx4 v10, s[24:27], s72 offen nt lds
  s_add_u32 s72, s72, 1024
  s_mov_b32 m0, s73
  s_add_u32 s73, s73, 1056
  buffer_load_dwordx4 v10, s[24:27], s72 offen nt lds
  s_add_u32 s72, s72, 1024
  s_mov_b32 m0, s73
  s_add_u32 s73, s73, 1056
  buffer_load_dwordx4 v10, s[24:27], s72 offen nt lds
  s_add_u32 s72, s72, 1024
  s_mov_b32 m0, s73
  s_add_u32 s73, s73, 1056
  buffer_load_dwordx4 v10, s[24:27], s72 offen nt lds
  s_add_u32 s72, s72, 1024
  s_mov_b32 m0, s73
  s_add_u32 s73, s73, 1056
  buffer_load_dwordx4 v10, s[24:27], s72 offen nt lds
  s_add_u32 s72, s72, 1024
  s_mov_b32 m0, s73
  s_add_u32 s73, s73, 1056
  buffer_load_dwordx4 v10, s[24:27], s72 offen nt lds
  s_add_u32 s72, s72, 1024
  s_mov_b32 s101, 0x00010001
  v_mov_b32 v30, 0x07060302
  s_lshr_b32 s48, s12, 0
  s_and_b32 s49, s48, 1
  s_lshl_b32 s48, s48, 15
  s_and_b32 s48, s48, 0x10000
  s_xor_b32 s7, s48, 0x10000
  s_lshl_b32 s6, s49, 16
  s_xor_b32 s6, s6, 0x10000
  s_or_b32 s48, s48, s49
  v_mov_b32 v56, s48
  s_lshr_b32 s48, s12, 2
  s_and_b32 s49, s48, 1
  s_lshl_b32 s48, s48, 15
  s_and_b32 s48, s48, 0x10000
  s_xor_b32 s79, s48, 0x10000
  s_lshl_b32 s78, s49, 16
  s_xor_b32 s78, s78, 0x10000
  s_or_b32 s48, s48, s49
  v_mov_b32 v57, s48
  s_lshr_b32 s48, s12, 4
  s_and_b32 s49, s48, 1
  s_lshl_b32 s48, s48, 15
  s_and_b32 s48, s48, 0x10000
  s_xor_b32 s85, s48, 0x10000
  s_lshl_b32 s84, s49, 16
  s_xor_b32 s84, s84, 0x10000
  s_or_b32 s48, s48, s49
  v_mov_b32 v58, s48
  s_lshr_b32 s48, s12, 6
  s_and_b32 s49, s48, 1
  s_lshl_b32 s48, s48, 15
  s_and_b32 s48, s48, 0x10000
  s_xor_b32 s87, s48, 0x10000
  s_lshl_b32 s86, s49, 16
  s_xor_b32 s86, s86, 0x10000
  s_or_b32 s48, s48, s49
  v_mov_b32 v59, s48
  s_branch L_DSTART
L_notF_35:
  s_mov_b32 m0, s73
  s_add_u32 s73, s73, 1056
  buffer_load_dwordx4 v10, s[24:27], s72 offen nt lds
  s_add_u32 s72, s72, 1024
  s_mov_b32 m0, s73
  s_add_u32 s73, s73, 1056
  buffer_load_dwordx4 v10, s[24:27], s72 offen nt lds
  s_add_u32 s72, s72, 1024
  s_mov_b32 m0, s73
  s_add_u32 s73, s73, 1056
  buffer_load_dwordx4 v10, s[24:27], s72 offen nt lds
  s_add_u32 s72, s72, 1024
  s_mov_b32 m0, s73
  s_add_u32 s73, s73, 1056
  buffer_load_dwordx4 v10, s[24:27], s72 offen nt lds
  s_add_u32 s72, s72, 1024
  s_mov_b32 m0, s73
  s_add_u32 s73, s73, 1056
  buffer_load_dwordx4 v10, s[24:27], s72 offen nt lds
  s_add_u32 s72, s72, 1024
  s_mov_b32 m0, s73
  s_add_u32 s73, s73, 1056
  buffer_load_dwordx4 v10, s[24:27], s72 offen nt lds
  s_add_u32 s72, s72, 1024
  s_mov_b32 m0, s73
  s_add_u32 s73, s73, 1056
  buffer_load_dwordx4 v10, s[24:27], s72 offen nt lds
  s_add_u32 s72, s72, 1024
  s_mov_b32 m0, s73
  s_add_u32 s73, s73, 1056
  buffer_load_dwordx4 v10, s[24:27], s72 offen nt lds
  s_add_u32 s72, s72, 1024
  s_mov_b32 m0, s73
  s_add_u32 s73, s73, 1056
  buffer_load_dwordx4 v10, s[24:27], s72 offen nt lds
  s_add_u32 s72, s72, 1024
  s_mov_b32 m0, s73
  s_add_u32 s73, s73, 1056
  buffer_load_dwordx4 v10, s[24:27], s72 offen nt lds
  s_add_u32 s72, s72, 1024
  s_mov_b32 m0, s73
  s_add_u32 s73, s73, 1056
  buffer_load_dwordx4 v10, s[24:27], s72 offen nt lds
  s_add_u32 s72, s72, 1024
  s_mov_b32 m0, s73
  s_add_u32 s73, s73, 1056
  buffer_load_dwordx4 v10, s[24:27], s72 offen nt lds
  s_add_u32 s72, s72, 1024
  s_mov_b32 m0, s73
  s_add_u32 s73, s73, 1056
  buffer_load_dwordx4 v10, s[24:27], s72 offen nt lds
  s_add_u32 s72, s72, 1024
  s_mov_b32 m0, s73
  s_add_u32 s73, s73, 1056
  buffer_load_dwordx4 v10, s[24:27], s72 offen nt lds
  s_add_u32 s72, s72, 1024
  s_mov_b32 m0, s73
  s_add_u32 s73, s73, 1056
  buffer_load_dwordx4 v10, s[24:27], s72 offen nt lds
  s_add_u32 s72, s72, 1024
  s_mov_b32 m0, s73
  s_add_u32 s73, s73, 1056
  buffer_load_dwordx4 v10, s[24:27], s72 offen nt lds
  s_add_u32 s72, s72, 1024
  s_mov_b32 m0, s73
  s_add_u32 s73, s73, 1056
  buffer_load_dwordx4 v10, s[24:27], s72 offen nt lds
  s_add_u32 s72, s72, 1024
  s_mov_b32 m0, s73
  s_add_u32 s73, s73, 1056
  buffer_load_dwordx4 v10, s[24:27], s72 offen nt lds
  s_add_u32 s72, s72, 1024
  s_mov_b32 m0, s73
  s_add_u32 s73, s73, 1056
  buffer_load_dwordx4 v10, s[24:27], s72 offen nt lds
  s_add_u32 s72, s72, 1024
  s_mov_b32 m0, s73
  s_add_u32 s73, s73, 1056
  buffer_load_dwordx4 v10, s[24:27], s72 offen nt lds
  s_add_u32 s72, s72, 1024
  s_mov_b32 m0, s73
  s_add_u32 s73, s73, 1056
  buffer_load_dwordx4 v10, s[24:27], s72 offen nt lds
  s_add_u32 s72, s72, 1024
  s_mov_b32 m0, s73
  s_add_u32 s73, s73, 1056
  buffer_load_dwordx4 v10, s[24:27], s72 offen nt lds
  s_add_u32 s72, s72, 1024
  s_mov_b32 m0, s73
  s_add_u32 s73, s73, 1056
  buffer_load_dwordx4 v10, s[24:27], s72 offen nt lds
  s_add_u32 s72, s72, 1024
  s_mov_b32 m0, s73
  s_add_u32 s73, s73, 1056
  buffer_load_dwordx4 v10, s[24:27], s72 offen nt lds
  s_add_u32 s72, s72, 1024
  s_mov_b32 m0, s73
  s_add_u32 s73, s73, 1056
  buffer_load_dwordx4 v10, s[24:27], s72 offen nt lds
  s_add_u32 s72, s72, 1024
  s_mov_b32 m0, s73
  s_add_u32 s73, s73, 1056
  buffer_load_dwordx4 v10, s[24:27], s72 offen nt lds
  s_add_u32 s72, s72, 1024
  s_mov_b32 m0, s73
  s_add_u32 s73, s73, 1056
  buffer_load_dwordx4 v10, s[24:27], s72 offen nt lds
  s_add_u32 s72, s72, 1024
  s_mov_b32 m0, s73
  s_add_u32 s73, s73, 1056
  buffer_load_dwordx4 v10, s[24:27], s72 offen nt lds
  s_add_u32 s72, s72, 1024
  s_mov_b32 m0, s73
  s_add_u32 s73, s73, 1056
  buffer_load_dwordx4 v10, s[24:27], s72 offen nt lds
  s_add_u32 s72, s72, 1024
  s_mov_b32 m0, s73
  s_add_u32 s73, s73, 1056
  buffer_load_dwordx4 v10, s[24:27], s72 offen nt lds
  s_add_u32 s72, s72, 1024
  s_mov_b32 m0, s73
  s_add_u32 s73, s73, 1056
  buffer_load_dwordx4 v10, s[24:27], s72 offen nt lds
  s_add_u32 s72, s72, 1024
  s_mov_b32 m0, s73
  s_add_u32 s73, s73, 1056
  buffer_load_dwordx4 v10, s[24:27], s72 offen nt lds
  s_add_u32 s72, s72, 1024
  s_load_dword s12, s[8:9], 0
  s_cmp_eq_u32 s22, 2
  s_cbranch_scc1 L_H1
  s_cmp_eq_u32 s22, 3
  s_cbranch_scc1 L_T1DONE
  v_cmp_gt_u32 vcc, 8, v2
  v_mov_b32 v6, s70
  v_mov_b32 v7, s68
  v_cndmask_b32 v12, v6, v7, vcc
  v_mov_b32 v6, s71
  v_mov_b32 v7, s69
  v_cndmask_b32 v13, v6, v7, vcc
  s_mul_i32 s48, s3, 160
  v_add_u32 v6, s48, v3
  v_mul_u32_u24 v6, 3456, v6
  v_and_b32 v7, 7, v2
  v_lshl_add_u32 v6, v7, 4, v6
  s_lshl_b32 s48, s23, 7
  v_add_u32 v6, s48, v6
  v_add_co_u32 v12, vcc, v12, v6
  s_nop 1
  v_addc_co_u32 v13, vcc, 0, v13, vcc
  global_load_dwordx4 a[0:3], v[12:13], off nt
  v_add_co_u32 v12, vcc, 13824, v12
  s_nop 1
  v_addc_co_u32 v13, vcc, 0, v13, vcc
  global_load_dwordx4 a[4:7], v[12:13], off nt
  v_add_co_u32 v12, vcc, 13824, v12
  s_nop 1
  v_addc_co_u32 v13, vcc, 0, v13, vcc
  global_load_dwordx4 a[8:11], v[12:13], off nt
  v_add_co_u32 v12, vcc, 13824, v12
  s_nop 1
  v_addc_co_u32 v13, vcc, 0, v13, vcc
  global_load_dwordx4 a[12:15], v[12:13], off nt
  v_add_co_u32 v12, vcc, 13824, v12
  s_nop 1
  v_addc_co_u32 v13, vcc, 0, v13, vcc
  global_load_dwordx4 a[16:19], v[12:13], off nt
  v_add_co_u32 v12, vcc, 13824, v12
  s_nop 1
  v_addc_co_u32 v13, vcc, 0, v13, vcc
  global_load_dwordx4 a[20:23], v[12:13], off nt
  v_add_co_u32 v12, vcc, 13824, v12
  s_nop 1
  v_addc_co_u32 v13, vcc, 0, v13, vcc
  global_load_dwordx4 a[24:27], v[12:13], off nt
  v_add_co_u32 v12, vcc, 13824, v12
  s_nop 1
  v_addc_co_u32 v13, vcc, 0, v13, vcc
  global_load_dwordx4 a[28:31], v[12:13], off nt
  v_add_co_u32 v12, vcc, 13824, v12
  s_nop 1
  v_addc_co_u32 v13, vcc, 0, v13, vcc
  global_load_dwordx4 a[32:35], v[12:13], off nt
  v_add_co_u32 v12, vcc, 13824, v12
  s_nop 1
  v_addc_co_u32 v13, vcc, 0, v13, vcc
  global_load_dwordx4 a[36:39], v[12:13], off nt
  v_add_co_u32 v12, vcc, 13824, v12
  s_nop 1
  v_addc_co_u32 v13, vcc, 0, v13, vcc
  global_load_dwordx4 a[40:43], v[12:13], off nt
  v_add_co_u32 v12, vcc, 13824, v12
  s_nop 1
  v_addc_co_u32 v13, vcc, 0, v13, vcc
  global_load_dwordx4 a[44:47], v[12:13], off nt
  v_add_co_u32 v12, vcc, 13824, v12
  s_nop 1
  v_addc_co_u32 v13, vcc, 0, v13, vcc
  global_load_dwordx4 a[48:51], v[12:13], off nt
  v_add_co_u32 v12, vcc, 13824, v12
  s_nop 1
  v_addc_co_u32 v13, vcc, 0, v13, vcc
  global_load_dwordx4 a[52:55], v[12:13], off nt
  v_add_co_u32 v12, vcc, 13824, v12
  s_nop 1
  v_addc_co_u32 v13, vcc, 0, v13, vcc
  global_load_dwordx4 a[56:59], v[12:13], off nt
  v_add_co_u32 v12, vcc, 13824, v12
  s_nop 1
  v_addc_co_u32 v13, vcc, 0, v13, vcc
  global_load_dwordx4 a[60:63], v[12:13], off nt
  v_add_co_u32 v12, vcc, 13824, v12
  s_nop 1
  v_addc_co_u32 v13, vcc, 0, v13, vcc
  global_load_dwordx4 a[64:67], v[12:13], off nt
  v_add_co_u32 v12, vcc, 13824, v12
  s_nop 1
  v_addc_co_u32 v13, vcc, 0, v13, vcc
  global_load_dwordx4 a[68:71], v[12:13], off nt
  v_add_co_u32 v12, vcc, 13824, v12
  s_nop 1
  v_addc_co_u32 v13, vcc, 0, v13, vcc
  global_load_dwordx4 a[72:75], v[12:13], off nt
  v_add_co_u32 v12, vcc, 13824, v12
  s_nop 1
  v_addc_co_u32 v13, vcc, 0, v13, vcc
  global_load_dwordx4 a[76:79], v[12:13], off nt
  v_add_co_u32 v12, vcc, 13824, v12
  s_nop 1
  v_addc_co_u32 v13, vcc, 0, v13, vcc
  global_load_dwordx4 a[80:83], v[12:13], off nt
  v_add_co_u32 v12, vcc, 13824, v12
  s_nop 1
  v_addc_co_u32 v13, vcc, 0, v13, vcc
  global_load_dwordx4 a[84:87], v[12:13], off nt
  v_add_co_u32 v12, vcc, 13824, v12
  s_nop 1
  v_addc_co_u32 v13, vcc, 0, v13, vcc
  global_load_dwordx4 a[88:91], v[12:13], off nt
  v_add_co_u32 v12, vcc, 13824, v12
  s_nop 1
  v_addc_co_u32 v13, vcc, 0, v13, vcc
  global_load_dwordx4 a[92:95], v[12:13], off nt
  v_add_co_u32 v12, vcc, 13824, v12
  s_nop 1
  v_addc_co_u32 v13, vcc, 0, v13, vcc
  s_branch L_T1DONE
L_H1:
  s_cmp_lg_u32 s18, 14
  s_cbranch_scc1 L_npf_38
  v_lshlrev_b32 v6, 4, v0
  global_load_dwordx4 v[32:35], v6, s[4:5]
  v_add_u32 v6, 4096, v6
  global_load_dwordx4 v[32:35], v6, s[4:5]
  v_add_u32 v6, 4096, v6
  global_load_dwordx4 v[32:35], v6, s[4:5]
  v_add_u32 v6, 4096, v6
  global_load_dwordx4 v[32:35], v6, s[4:5]
  v_add_u32 v6, 4096, v6
  global_load_dwordx4 v[32:35], v6, s[4:5]
  v_add_u32 v6, 4096, v6
  global_load_dwordx4 v[32:35], v6, s[4:5]
  v_add_u32 v6, 4096, v6
  global_load_dwordx4 v[32:35], v6, s[4:5]
  v_add_u32 v6, 4096, v6
  global_load_dwordx4 v[32:35], v6, s[4:5]
  v_add_u32 v6, 4096, v6
  global_load_dwordx4 v[32:35], v6, s[4:5]
L_npf_38:
  v_lshrrev_b32 v6, 2, v1
  v_mul_u32_u24 v6, 1280, v6
  v_and_b32 v7, 3, v1
  v_lshl_add_u32 v12, v7, 4, v6
  s_mul_i32 s76, s3, 552960
  s_lshl_b32 s48, s23, 6
  s_add_u32 s76, s76, s48
  buffer_load_dwordx4 a[0:3], v12, s[52:55], s76 offen nt
  s_add_u32 s76, s76, 20480
  buffer_load_dwordx4 a[4:7], v12, s[52:55], s76 offen nt
  s_add_u32 s76, s76, 20480
  buffer_load_dwordx4 a[8:11], v12, s[52:55], s76 offen nt
  s_add_u32 s76, s76, 20480
  buffer_load_dwordx4 a[12:15], v12, s[52:55], s76 offen nt
  s_add_u32 s76, s76, 20480
  buffer_load_dwordx4 a[16:19], v12, s[52:55], s76 offen nt
  s_add_u32 s76, s76, 20480
  buffer_load_dwordx4 a[20:23], v12, s[52:55], s76 offen nt
  s_add_u32 s76, s76, 20480
  buffer_load_dwordx4 a[24:27], v12, s[52:55], s76 offen nt
  s_add_u32 s76, s76, 20480
  buffer_load_dwordx4 a[28:31], v12, s[52:55], s76 offen nt
  s_add_u32 s76, s76, 20480
  buffer_load_dwordx4 a[32:35], v12, s[52:55], s76 offen nt
  s_add_u32 s76, s76, 20480
  buffer_load_dwordx4 a[36:39], v12, s[52:55], s76 offen nt
  s_add_u32 s76, s76, 20480
L_T1DONE:
  s_waitcnt lgkmcnt(0)
  s_and_b32 s12, s12, 0xff
  s_add_u32 s12, s12, 1
  s_cmp_eq_u32 s12, 256
  s_cselect_b32 s12, 1, s12
  s_mul_i32 s13, s12, 0x01010101
  v_mov_b32 v4, s12
  s_mov_b32 s101, 0x00010001
  v_mov_b32 v30, 0x07060302
  s_lshr_b32 s48, s12, 0
  s_and_b32 s49, s48, 1
  s_lshl_b32 s48, s48, 15
  s_and_b32 s48, s48, 0x10000
  s_xor_b32 s7, s48, 0x10000
  s_lshl_b32 s6, s49, 16
  s_xor_b32 s6, s6, 0x10000
  s_or_b32 s48, s48, s49
  v_mov_b32 v56, s48
  s_lshr_b32 s48, s12, 2
  s_and_b32 s49, s48, 1
  s_lshl_b32 s48, s48, 15
  s_and_b32 s48, s48, 0x10000
  s_xor_b32 s79, s48, 0x10000
  s_lshl_b32 s78, s49, 16
  s_xor_b32 s78, s78, 0x10000
  s_or_b32 s48, s48, s49
  v_mov_b32 v57, s48
  s_lshr_b32 s48, s12, 4
  s_and_b32 s49, s48, 1
  s_lshl_b32 s48, s48, 15
  s_and_b32 s48, s48, 0x10000
  s_xor_b32 s85, s48, 0x10000
  s_lshl_b32 s84, s49, 16
  s_xor_b32 s84, s84, 0x10000
  s_or_b32 s48, s48, s49
  v_mov_b32 v58, s48
  s_lshr_b32 s48, s12, 6
  s_and_b32 s49, s48, 1
  s_lshl_b32 s48, s48, 15
  s_and_b32 s48, s48, 0x10000
  s_xor_b32 s87, s48, 0x10000
  s_lshl_b32 s86, s49, 16
  s_xor_b32 s86, s86, 0x10000
  s_or_b32 s48, s48, s49
  v_mov_b32 v59, s48
L_DSTART:
  s_lshl_b32 s48, s3, 5
  v_add_u32 v6, s48, v2
  v_mul_u32_u24 v14, 1056, v6
  v_lshl_add_u32 v14, v3, 4, v14
  s_mul_i32 s48, s3, 1056
  s_add_u32 s48, s48, 135168
  v_add_u32 v15, s48, v10
  v_mul_u32_u24 v17, 1056, v2
  v_lshl_add_u32 v17, v3, 4, v17
  v_add_u32 v17, 135168, v17
  v_lshrrev_b32 v6, 2, v1
  v_mul_u32_u24 v18, 1056, v6
  v_and_b32 v7, 3, v1
  v_lshl_add_u32 v18, v7, 3, v18
  s_lshl_b32 s48, s3, 8
  v_add_u32 v18, s48, v18
  v_add_u32 v19, 67584, v18
  s_lshl_b32 s48, s3, 2
  v_add_u32 v6, s48, v3
  v_lshl_add_u32 v6, v2, 4, v6
  v_lshlrev_b32 v20, 2, v6
  v_add_u32 v20, 156160, v20
  v_lshlrev_b32 v21, 6, v2
  v_add_u32 v21, 156160, v21
  v_lshl_add_u32 v6, v2, 2, v3
  v_lshlrev_b32 v23, 4, v6
  v_add_u32 v23, 152064, v23
  s_lshl_b32 s48, s3, 10
  v_add_u32 v22, s48, v23
  s_lshl_b32 s60, s19, 5
  s_lshl_b32 s48, s21, 4
  s_add_u32 s77, s60, s48
  s_add_u32 s60, s77, s3
  s_lshl_b32 s60, s60, 10
  s_add_u32 s80, s60, 393216
  s_add_u32 s81, s80, 4096
  s_add_u32 s82, s80, 8192
  s_add_u32 s83, s80, 12288
  s_waitcnt vmcnt(0)
  s_barrier
  ds_read_b128 v[128:131], v14 offset:0
  ds_read_b128 v[132:135], v14 offset:64
  ds_read_b128 v[136:139], v14 offset:128
  ds_read_b128 v[140:143], v14 offset:192
  ds_read_b128 v[144:147], v14 offset:256
  ds_read_b128 v[148:151], v14 offset:320
  ds_read_b128 v[152:155], v14 offset:384
  ds_read_b128 v[156:159], v14 offset:448
  ds_read_b128 v[160:163], v14 offset:512
  ds_read_b128 v[164:167], v14 offset:576
  ds_read_b128 v[168:171], v14 offset:640
  ds_read_b128 v[172:175], v14 offset:704
  ds_read_b128 v[176:179], v14 offset:768
  ds_read_b128 v[180:183], v14 offset:832
  ds_read_b128 v[184:187], v14 offset:896
  ds_read_b128 v[188:191], v14 offset:960
  ds_read_b128 v[192:195], v14 offset:16896
  ds_read_b128 v[196:199], v14 offset:16960
  ds_read_b128 v[200:203], v14 offset:17024
  ds_read_b128 v[204:207], v14 offset:17088
  ds_read_b128 v[208:211], v14 offset:17152
  ds_read_b128 v[212:215], v14 offset:17216
  ds_read_b128 v[216:219], v14 offset:17280
  ds_read_b128 v[220:223], v14 offset:17344
  ds_read_b128 v[224:227], v14 offset:17408
  ds_read_b128 v[228:231], v14 offset:17472
  ds_read_b128 v[232:235], v14 offset:17536
  ds_read_b128 v[236:239], v14 offset:17600
  ds_read_b128 v[240:243], v14 offset:17664
  ds_read_b128 v[244:247], v14 offset:17728
  ds_read_b128 v[248:251], v14 offset:17792
  ds_read_b128 v[252:255], v14 offset:17856
  ds_read_b64_tr_b16 a[128:129], v18 offset:0
  ds_read_b64_tr_b16 a[130:131], v18 offset:16896
  ds_read_b64_tr_b16 a[132:133], v18 offset:33792
  ds_read_b64_tr_b16 a[134:135], v18 offset:50688
  ds_read_b64_tr_b16 a[136:137], v19 offset:0
  ds_read_b64_tr_b16 a[138:139], v19 offset:16896
  ds_read_b64_tr_b16 a[140:141], v19 offset:33792
  ds_read_b64_tr_b16 a[142:143], v19 offset:50688
  ds_read_b64_tr_b16 a[144:145], v18 offset:32
  ds_read_b64_tr_b16 a[146:147], v18 offset:16928
  ds_read_b64_tr_b16 a[148:149], v18 offset:33824
  ds_read_b64_tr_b16 a[150:151], v18 offset:50720
  ds_read_b64_tr_b16 a[152:153], v19 offset:32
  ds_read_b64_tr_b16 a[154:155], v19 offset:16928
  ds_read_b64_tr_b16 a[156:157], v19 offset:33824
  ds_read_b64_tr_b16 a[158:159], v19 offset:50720
  ds_read_b64_tr_b16 a[160:161], v18 offset:64
  ds_read_b64_tr_b16 a[162:163], v18 offset:16960
  ds_read_b64_tr_b16 a[164:165], v18 offset:33856
  ds_read_b64_tr_b16 a[166:167], v18 offset:50752
  ds_read_b64_tr_b16 a[168:169], v19 offset:64
  ds_read_b64_tr_b16 a[170:171], v19 offset:16960
  ds_read_b64_tr_b16 a[172:173], v19 offset:33856
  ds_read_b64_tr_b16 a[174:175], v19 offset:50752
  ds_read_b64_tr_b16 a[176:177], v18 offset:96
  ds_read_b64_tr_b16 a[178:179], v18 offset:16992
  ds_read_b64_tr_b16 a[180:181], v18 offset:33888
  ds_read_b64_tr_b16 a[182:183], v18 offset:50784
  ds_read_b64_tr_b16 a[184:185], v19 offset:96
  ds_read_b64_tr_b16 a[186:187], v19 offset:16992
  ds_read_b64_tr_b16 a[188:189], v19 offset:33888
  ds_read_b64_tr_b16 a[190:191], v19 offset:50784
  ds_read_b64_tr_b16 a[192:193], v18 offset:128
  ds_read_b64_tr_b16 a[194:195], v18 offset:17024
  ds_read_b64_tr_b16 a[196:197], v18 offset:33920
  ds_read_b64_tr_b16 a[198:199], v18 offset:50816
  ds_read_b64_tr_b16 a[200:201], v19 offset:128
  ds_read_b64_tr_b16 a[202:203], v19 offset:17024
  ds_read_b64_tr_b16 a[204:205], v19 offset:33920
  ds_read_b64_tr_b16 a[206:207], v19 offset:50816
  ds_read_b64_tr_b16 a[208:209], v18 offset:160
  ds_read_b64_tr_b16 a[210:211], v18 offset:17056
  ds_read_b64_tr_b16 a[212:213], v18 offset:33952
  ds_read_b64_tr_b16 a[214:215], v18 offset:50848
  ds_read_b64_tr_b16 a[216:217], v19 offset:160
  ds_read_b64_tr_b16 a[218:219], v19 offset:17056
  ds_read_b64_tr_b16 a[220:221], v19 offset:33952
  ds_read_b64_tr_b16 a[222:223], v19 offset:50848
  ds_read_b64_tr_b16 a[224:225], v18 offset:192
  ds_read_b64_tr_b16 a[226:227], v18 offset:17088
  ds_read_b64_tr_b16 a[228:229], v18 offset:33984
  ds_read_b64_tr_b16 a[230:231], v18 offset:50880
  ds_read_b64_tr_b16 a[232:233], v19 offset:192
  ds_read_b64_tr_b16 a[234:235], v19 offset:17088
  ds_read_b64_tr_b16 a[236:237], v19 offset:33984
  ds_read_b64_tr_b16 a[238:239], v19 offset:50880
  ds_read_b64_tr_b16 a[240:241], v18 offset:224
  ds_read_b64_tr_b16 a[242:243], v18 offset:17120
  ds_read_b64_tr_b16 a[244:245], v18 offset:34016
  ds_read_b64_tr_b16 a[246:247], v18 offset:50912
  ds_read_b64_tr_b16 a[248:249], v19 offset:224
  ds_read_b64_tr_b16 a[250:251], v19 offset:17120
  ds_read_b64_tr_b16 a[252:253], v19 offset:34016
  ds_read_b64_tr_b16 a[254:255], v19 offset:50912
  s_mov_b32 s48, 7168
  v_and_b32 v7, 7, v1
  v_lshlrev_b32 v7, 7, v7
L_db_39:
  buffer_load_dword v6, v7, s[8:11], s48 offen sc1
  s_waitcnt vmcnt(0)
  v_cmp_ne_u32 vcc, s13, v6
  s_nop 0
  s_cbranch_vccz L_dbd_40
  s_sleep 1
  s_add_u32 s15, s15, 1
  s_cmp_lt_u32 s15, 100000
  s_cbranch_scc1 L_db_39
L_dbd_40:
  buffer_load_dwordx4 v[32:35], v10, s[8:11], s80 offen sc1
  buffer_load_dwordx4 v[36:39], v10, s[8:11], s81 offen sc1
  buffer_load_dwordx4 v[40:43], v10, s[8:11], s82 offen sc1
  buffer_load_dwordx4 v[44:47], v10, s[8:11], s83 offen sc1
  v_mov_b32 v6, 0
  s_waitcnt vmcnt(3)
  v_xor_b32 v8, v32, v56
  v_xor_b32 v9, v33, v57
  v_or3_b32 v6, v6, v8, v9
  v_xor_b32 v8, v34, v58
  v_xor_b32 v9, v35, v59
  v_or3_b32 v6, v6, v8, v9
  s_waitcnt vmcnt(2)
  v_xor_b32 v8, v36, v56
  v_xor_b32 v9, v37, v57
  v_or3_b32 v6, v6, v8, v9
  v_xor_b32 v8, v38, v58
  v_xor_b32 v9, v39, v59
  v_or3_b32 v6, v6, v8, v9
  s_waitcnt vmcnt(1)
  v_xor_b32 v8, v40, v56
  v_xor_b32 v9, v41, v57
  v_or3_b32 v6, v6, v8, v9
  v_xor_b32 v8, v42, v58
  v_xor_b32 v9, v43, v59
  v_or3_b32 v6, v6, v8, v9
  s_waitcnt vmcnt(0)
  v_xor_b32 v8, v44, v56
  v_xor_b32 v9, v45, v57
  v_or3_b32 v6, v6, v8, v9
  v_xor_b32 v8, v46, v58
  v_xor_b32 v9, v47, v59
  v_or3_b32 v6, v6, v8, v9
  v_and_b32 v6, s101, v6
  v_cmp_ne_u32 vcc, 0, v6
  s_nop 0
  s_cbranch_vccz L_pld_41
L_pls_42:
  s_mov_b32 s100, 0
  v_mov_b32 v6, 0
  v_xor_b32 v8, v32, v56
  v_xor_b32 v9, v33, v57
  v_or3_b32 v6, v6, v8, v9
  v_xor_b32 v8, v34, v58
  v_xor_b32 v9, v35, v59
  v_or3_b32 v6, v6, v8, v9
  v_and_b32 v6, s101, v6
  v_cmp_ne_u32 vcc, 0, v6
  s_nop 0
  s_cbranch_vccz L_plk_43
  buffer_load_dwordx4 v[32:35], v10, s[8:11], s80 offen sc1
  s_mov_b32 s100, 1
L_plk_43:
  v_mov_b32 v6, 0
  v_xor_b32 v8, v36, v56
  v_xor_b32 v9, v37, v57
  v_or3_b32 v6, v6, v8, v9
  v_xor_b32 v8, v38, v58
  v_xor_b32 v9, v39, v59
  v_or3_b32 v6, v6, v8, v9
  v_and_b32 v6, s101, v6
  v_cmp_ne_u32 vcc, 0, v6
  s_nop 0
  s_cbranch_vccz L_plk_44
  buffer_load_dwordx4 v[36:39], v10, s[8:11], s81 offen sc1
  s_mov_b32 s100, 1
L_plk_44:
  v_mov_b32 v6, 0
  v_xor_b32 v8, v40, v56
  v_xor_b32 v9, v41, v57
  v_or3_b32 v6, v6, v8, v9
  v_xor_b32 v8, v42, v58
  v_xor_b32 v9, v43, v59
  v_or3_b32 v6, v6, v8, v9
  v_and_b32 v6, s101, v6
  v_cmp_ne_u32 vcc, 0, v6
  s_nop 0
  s_cbranch_vccz L_plk_45
  buffer_load_dwordx4 v[40:43], v10, s[8:11], s82 offen sc1
  s_mov_b32 s100, 1
L_plk_45:
  v_mov_b32 v6, 0
  v_xor_b32 v8, v44, v56
  v_xor_b32 v9, v45, v57
  v_or3_b32 v6, v6, v8, v9
  v_xor_b32 v8, v46, v58
  v_xor_b32 v9, v47, v59
  v_or3_b32 v6, v6, v8, v9
  v_and_b32 v6, s101, v6
  v_cmp_ne_u32 vcc, 0, v6
  s_nop 0
  s_cbranch_vccz L_plk_46
  buffer_load_dwordx4 v[44:47], v10, s[8:11], s83 offen sc1
  s_mov_b32 s100, 1
L_plk_46:
  s_cmp_eq_u32 s100, 0
  s_cbranch_scc1 L_pld_41
  s_waitcnt vmcnt(0)
  s_add_u32 s15, s15, 1
  s_cmp_lt_u32 s15, 100000
  s_cbranch_scc1 L_pls_42
L_pld_41:
  ds_write_b128 v15, v[32:35] offset:0
  ds_write_b128 v15, v[36:39] offset:4224
  ds_write_b128 v15, v[40:43] offset:8448
  ds_write_b128 v15, v[44:47] offset:12672
  s_waitcnt lgkmcnt(0)
  s_barrier
  ds_read_b128 v[64:67], v17 offset:0
  ds_read_b128 v[68:71], v17 offset:64
  ds_read_b128 v[72:75], v17 offset:128
  ds_read_b128 v[76:79], v17 offset:192
  ds_read_b128 v[80:83], v17 offset:256
  ds_read_b128 v[84:87], v17 offset:320
  ds_read_b128 v[88:91], v17 offset:384
  ds_read_b128 v[92:95], v17 offset:448
  ds_read_b128 v[96:99], v17 offset:512
  ds_read_b128 v[100:103], v17 offset:576
  ds_read_b128 v[104:107], v17 offset:640
  ds_read_b128 v[108:111], v17 offset:704
  ds_read_b128 v[112:115], v17 offset:768
  ds_read_b128 v[116:119], v17 offset:832
  ds_read_b128 v[120:123], v17 offset:896
  ds_read_b128 v[124:127], v17 offset:960
  v_mov_b32 v32, 0
  v_mov_b32 v33, 0
  v_mov_b32 v34, 0
  v_mov_b32 v35, 0
  v_mov_b32 v36, 0
  v_mov_b32 v37, 0
  v_mov_b32 v38, 0
  v_mov_b32 v39, 0
  s_waitcnt lgkmcnt(15)
  v_mfma_f32_16x16x32_bf16 v[32:35], v[128:131], v[64:67], v[32:35]
  v_mfma_f32_16x16x32_bf16 v[36:39], v[192:195], v[64:67], v[36:39]
  s_waitcnt lgkmcnt(14)
  v_mfma_f32_16x16x32_bf16 v[32:35], v[132:135], v[68:71], v[32:35]
  v_mfma_f32_16x16x32_bf16 v[36:39], v[196:199], v[68:71], v[36:39]
  s_waitcnt lgkmcnt(13)
  v_mfma_f32_16x16x32_bf16 v[32:35], v[136:139], v[72:75], v[32:35]
  v_mfma_f32_16x16x32_bf16 v[36:39], v[200:203], v[72:75], v[36:39]
  s_waitcnt lgkmcnt(12)
  v_mfma_f32_16x16x32_bf16 v[32:35], v[140:143], v[76:79], v[32:35]
  v_mfma_f32_16x16x32_bf16 v[36:39], v[204:207], v[76:79], v[36:39]
  s_waitcnt lgkmcnt(11)
  v_mfma_f32_16x16x32_bf16 v[32:35], v[144:147], v[80:83], v[32:35]
  v_mfma_f32_16x16x32_bf16 v[36:39], v[208:211], v[80:83], v[36:39]
  s_waitcnt lgkmcnt(10)
  v_mfma_f32_16x16x32_bf16 v[32:35], v[148:151], v[84:87], v[32:35]
  v_mfma_f32_16x16x32_bf16 v[36:39], v[212:215], v[84:87], v[36:39]
  s_waitcnt lgkmcnt(9)
  v_mfma_f32_16x16x32_bf16 v[32:35], v[152:155], v[88:91], v[32:35]
  v_mfma_f32_16x16x32_bf16 v[36:39], v[216:219], v[88:91], v[36:39]
  s_waitcnt lgkmcnt(8)
  v_mfma_f32_16x16x32_bf16 v[32:35], v[156:159], v[92:95], v[32:35]
  v_mfma_f32_16x16x32_bf16 v[36:39], v[220:223], v[92:95], v[36:39]
  s_waitcnt lgkmcnt(7)
  v_mfma_f32_16x16x32_bf16 v[32:35], v[160:163], v[96:99], v[32:35]
  v_mfma_f32_16x16x32_bf16 v[36:39], v[224:227], v[96:99], v[36:39]
  s_waitcnt lgkmcnt(6)
  v_mfma_f32_16x16x32_bf16 v[32:35], v[164:167], v[100:103], v[32:35]
  v_mfma_f32_16x16x32_bf16 v[36:39], v[228:231], v[100:103], v[36:39]
  s_waitcnt lgkmcnt(5)
  v_mfma_f32_16x16x32_bf16 v[32:35], v[168:171], v[104:107], v[32:35]
  v_mfma_f32_16x16x32_bf16 v[36:39], v[232:235], v[104:107], v[36:39]
  s_waitcnt lgkmcnt(4)
  v_mfma_f32_16x16x32_bf16 v[32:35], v[172:175], v[108:111], v[32:35]
  v_mfma_f32_16x16x32_bf16 v[36:39], v[236:239], v[108:111], v[36:39]
  s_waitcnt lgkmcnt(3)
  v_mfma_f32_16x16x32_bf16 v[32:35], v[176:179], v[112:115], v[32:35]
  v_mfma_f32_16x16x32_bf16 v[36:39], v[240:243], v[112:115], v[36:39]
  s_waitcnt lgkmcnt(2)
  v_mfma_f32_16x16x32_bf16 v[32:35], v[180:183], v[116:119], v[32:35]
  v_mfma_f32_16x16x32_bf16 v[36:39], v[244:247], v[116:119], v[36:39]
  s_waitcnt lgkmcnt(1)
  v_mfma_f32_16x16x32_bf16 v[32:35], v[184:187], v[120:123], v[32:35]
  v_mfma_f32_16x16x32_bf16 v[36:39], v[248:251], v[120:123], v[36:39]
  s_waitcnt lgkmcnt(0)
  v_mfma_f32_16x16x32_bf16 v[32:35], v[188:191], v[124:127], v[32:35]
  v_mfma_f32_16x16x32_bf16 v[36:39], v[252:255], v[124:127], v[36:39]
  s_nop 6
  v_max3_f32 v40, v32, v33, v34
  v_max3_f32 v40, v40, v35, v36
  v_max3_f32 v40, v40, v37, v38
  v_max_f32 v40, v40, v39
  ds_write_b32 v20, v40
  s_waitcnt lgkmcnt(0)
  s_barrier
  ds_read_b128 v[96:99], v21 offset:0
  ds_read_b128 v[100:103], v21 offset:16
  ds_read_b128 v[104:107], v21 offset:32
  ds_read_b128 v[108:111], v21 offset:48
  s_waitcnt lgkmcnt(0)
  v_max3_f32 v40, v96, v97, v98
  v_max3_f32 v40, v40, v99, v100
  v_max3_f32 v40, v40, v101, v102
  v_max3_f32 v40, v40, v103, v104
  v_max3_f32 v40, v40, v105, v106
  v_max3_f32 v40, v40, v107, v108
  v_max3_f32 v40, v40, v109, v110
  v_max_f32 v40, v40, v111
  v_and_b32 v40, 0xffffff00, v40
  v_mul_f32 v41, 0xbe0293ee, v40
  s_mov_b32 s48, 0x3e0293ee
  v_fma_f32 v32, v32, s48, v41
  v_fma_f32 v33, v33, s48, v41
  v_fma_f32 v34, v34, s48, v41
  v_fma_f32 v35, v35, s48, v41
  v_fma_f32 v36, v36, s48, v41
  v_fma_f32 v37, v37, s48, v41
  v_fma_f32 v38, v38, s48, v41
  v_fma_f32 v39, v39, s48, v41
  v_exp_f32 v32, v32
  v_exp_f32 v33, v33
  v_exp_f32 v34, v34
  v_exp_f32 v35, v35
  v_exp_f32 v36, v36
  v_exp_f32 v37, v37
  v_exp_f32 v38, v38
  v_exp_f32 v39, v39
  v_cvt_pk_bf16_f32 v44, v32, v33
  v_cvt_pk_bf16_f32 v45, v34, v35
  v_cvt_pk_bf16_f32 v46, v36, v37
  v_cvt_pk_bf16_f32 v47, v38, v39
  ds_write_b128 v22, v[44:47]
  v_add_f32 v42, v32, v33
  v_add_f32 v42, v42, v34
  v_add_f32 v42, v42, v35
  v_add_f32 v42, v42, v36
  v_add_f32 v42, v42, v37
  v_add_f32 v42, v42, v38
  v_add_f32 v42, v42, v39
  ds_write_b32 v20, v42 offset:1024
  v_mov_b32 v64, 0
  v_mov_b32 v65, 0
  v_mov_b32 v66, 0
  v_mov_b32 v67, 0
  v_mov_b32 v68, 0
  v_mov_b32 v69, 0
  v_mov_b32 v70, 0
  v_mov_b32 v71, 0
  v_mov_b32 v72, 0
  v_mov_b32 v73, 0
  v_mov_b32 v74, 0
  v_mov_b32 v75, 0
  v_mov_b32 v76, 0
  v_mov_b32 v77, 0
  v_mov_b32 v78, 0
  v_mov_b32 v79, 0
  v_mov_b32 v80, 0
  v_mov_b32 v81, 0
  v_mov_b32 v82, 0
  v_mov_b32 v83, 0
  v_mov_b32 v84, 0
  v_mov_b32 v85, 0
  v_mov_b32 v86, 0
  v_mov_b32 v87, 0
  v_mov_b32 v88, 0
  v_mov_b32 v89, 0
  v_mov_b32 v90, 0
  v_mov_b32 v91, 0
  v_mov_b32 v92, 0
  v_mov_b32 v93, 0
  v_mov_b32 v94, 0
  v_mov_b32 v95, 0
  s_waitcnt lgkmcnt(0)
  s_barrier
  ds_read_b128 v[128:131], v23 offset:0
  ds_read_b128 v[132:135], v23 offset:1024
  ds_read_b128 v[136:139], v23 offset:2048
  ds_read_b128 v[140:143], v23 offset:3072
  ds_read_b128 v[96:99], v21 offset:1024
  ds_read_b128 v[100:103], v21 offset:1040
  ds_read_b128 v[104:107], v21 offset:1056
  ds_read_b128 v[108:111], v21 offset:1072
  v_and_b32 v7, 7, v2
  v_lshlrev_b32 v7, 16, v7
  v_lshl_add_u32 v7, v3, 4, v7
  v_lshrrev_b32 v8, 3, v2
  v_lshl_add_u32 v7, v8, 6, v7
  s_lshl_b32 s61, s21, 6
  s_add_u32 s61, s61, s3
  s_lshl_b32 s61, s61, 1
  s_add_u32 s61, s61, s19
  s_lshl_b32 s61, s61, 13
  s_lshl_b32 s48, s20, 8
  s_add_u32 s61, s61, s48
  s_add_u32 s61, s61, 1048576
  s_add_u32 s62, s61, 524288
  v_lshlrev_b32 v6, 11, v2
  s_lshl_b32 s60, s77, 2
  s_add_u32 s60, s60, s3
  s_lshl_b32 s60, s60, 5
  s_add_u32 s60, s60, s20
  s_lshl_b32 s60, s60, 4
  s_add_u32 s60, s60, 5242880
  s_waitcnt lgkmcnt(4)
  v_mfma_f32_16x16x32_bf16 v[64:67], a[128:131], v[128:131], v[64:67]
  v_mfma_f32_16x16x32_bf16 v[68:71], a[144:147], v[128:131], v[68:71]
  v_mfma_f32_16x16x32_bf16 v[64:67], a[132:135], v[132:135], v[64:67]
  v_mfma_f32_16x16x32_bf16 v[68:71], a[148:151], v[132:135], v[68:71]
  v_mfma_f32_16x16x32_bf16 v[64:67], a[136:139], v[136:139], v[64:67]
  v_mfma_f32_16x16x32_bf16 v[68:71], a[152:155], v[136:139], v[68:71]
  v_mfma_f32_16x16x32_bf16 v[64:67], a[140:143], v[140:143], v[64:67]
  v_mfma_f32_16x16x32_bf16 v[68:71], a[156:159], v[140:143], v[68:71]
  s_waitcnt lgkmcnt(0)
  v_add_f32 v41, v96, v97
  v_add_f32 v41, v41, v98
  v_add_f32 v41, v41, v99
  v_add_f32 v41, v41, v100
  v_add_f32 v41, v41, v101
  v_add_f32 v41, v41, v102
  v_add_f32 v41, v41, v103
  v_add_f32 v41, v41, v104
  v_add_f32 v41, v41, v105
  v_add_f32 v41, v41, v106
  v_add_f32 v41, v41, v107
  v_add_f32 v41, v41, v108
  v_add_f32 v41, v41, v109
  v_add_f32 v41, v41, v110
  v_add_f32 v41, v41, v111
  v_mov_b32 v42, 0
  v_mov_b32 v43, 0
  v_bfi_b32 v40, s14, v4, v40
  v_bfi_b32 v41, s14, v4, v41
  v_bfi_b32 v42, s14, v4, v42
  v_bfi_b32 v43, s14, v4, v43
  v_cmp_gt_u32 vcc, 16, v1
  s_nop 0
  s_and_saveexec_b64 s[44:45], vcc
  buffer_store_dwordx4 v[40:43], v6, s[8:11], s60 offen sc1
  s_mov_b64 exec, s[44:45]
  s_cmp_ge_u32 s16, 8
  s_cbranch_scc1 L_nr_47
  s_cmp_lg_u32 s3, 0
  s_cbranch_scc1 L_nr_47
  v_mov_b32 v9, s13
  s_lshl_b32 s48, s17, 7
  s_add_u32 s48, s48, 8192
  s_mov_b64 s[44:45], exec
  s_mov_b64 exec, 1
  buffer_store_dword v9, v5, s[8:11], s48 offen sc1
  s_mov_b64 exec, s[44:45]
L_nr_47:
  v_mfma_f32_16x16x32_bf16 v[72:75], a[160:163], v[128:131], v[72:75]
  v_mfma_f32_16x16x32_bf16 v[76:79], a[176:179], v[128:131], v[76:79]
  v_mfma_f32_16x16x32_bf16 v[72:75], a[164:167], v[132:135], v[72:75]
  v_mfma_f32_16x16x32_bf16 v[76:79], a[180:183], v[132:135], v[76:79]
  v_mfma_f32_16x16x32_bf16 v[72:75], a[168:171], v[136:139], v[72:75]
  v_mfma_f32_16x16x32_bf16 v[76:79], a[184:187], v[136:139], v[76:79]
  v_mfma_f32_16x16x32_bf16 v[72:75], a[172:175], v[140:143], v[72:75]
  v_mfma_f32_16x16x32_bf16 v[76:79], a[188:191], v[140:143], v[76:79]
  v_add_u32 v64, s6, v64
  v_add_u32 v65, s7, v65
  v_perm_b32 v144, v65, v64, v30
  v_add_u32 v66, s78, v66
  v_add_u32 v67, s79, v67
  v_perm_b32 v145, v67, v66, v30
  v_add_u32 v68, s84, v68
  v_add_u32 v69, s85, v69
  v_perm_b32 v146, v69, v68, v30
  v_add_u32 v70, s86, v70
  v_add_u32 v71, s87, v71
  v_perm_b32 v147, v71, v70, v30
  v_mfma_f32_16x16x32_bf16 v[80:83], a[192:195], v[128:131], v[80:83]
  v_mfma_f32_16x16x32_bf16 v[84:87], a[208:211], v[128:131], v[84:87]
  v_mfma_f32_16x16x32_bf16 v[80:83], a[196:199], v[132:135], v[80:83]
  v_mfma_f32_16x16x32_bf16 v[84:87], a[212:215], v[132:135], v[84:87]
  v_mfma_f32_16x16x32_bf16 v[80:83], a[200:203], v[136:139], v[80:83]
  v_mfma_f32_16x16x32_bf16 v[84:87], a[216:219], v[136:139], v[84:87]
  v_mfma_f32_16x16x32_bf16 v[80:83], a[204:207], v[140:143], v[80:83]
  v_mfma_f32_16x16x32_bf16 v[84:87], a[220:223], v[140:143], v[84:87]
  v_add_u32 v72, s6, v72
  v_add_u32 v73, s7, v73
  v_perm_b32 v148, v73, v72, v30
  v_add_u32 v74, s78, v74
  v_add_u32 v75, s79, v75
  v_perm_b32 v149, v75, v74, v30
  v_add_u32 v76, s84, v76
  v_add_u32 v77, s85, v77
  v_perm_b32 v150, v77, v76, v30
  v_add_u32 v78, s86, v78
  v_add_u32 v79, s87, v79
  v_perm_b32 v151, v79, v78, v30
  v_mov_b32 v112, v144
  v_mov_b32 v113, v145
  v_mov_b32 v114, v146
  v_mov_b32 v115, v147
  v_mov_b32_dpp v144, v148 row_ror:8 row_mask:0xf bank_mask:0xc
  v_mov_b32_dpp v145, v149 row_ror:8 row_mask:0xf bank_mask:0xc
  v_mov_b32_dpp v146, v150 row_ror:8 row_mask:0xf bank_mask:0xc
  v_mov_b32_dpp v147, v151 row_ror:8 row_mask:0xf bank_mask:0xc
  v_mov_b32_dpp v148, v112 row_ror:8 row_mask:0xf bank_mask:0x3
  v_mov_b32_dpp v149, v113 row_ror:8 row_mask:0xf bank_mask:0x3
  v_mov_b32_dpp v150, v114 row_ror:8 row_mask:0xf bank_mask:0x3
  v_mov_b32_dpp v151, v115 row_ror:8 row_mask:0xf bank_mask:0x3
  v_bfi_b32 v144, s101, v56, v144
  v_bfi_b32 v145, s101, v57, v145
  v_bfi_b32 v146, s101, v58, v146
  v_bfi_b32 v147, s101, v59, v147
  v_bfi_b32 v148, s101, v56, v148
  v_bfi_b32 v149, s101, v57, v149
  v_bfi_b32 v150, s101, v58, v150
  v_bfi_b32 v151, s101, v59, v151
  buffer_store_dwordx4 v[144:147], v7, s[8:11], s61 offen offset:0 sc1
  buffer_store_dwordx4 v[148:151], v7, s[8:11], s62 offen offset:0 sc1
  v_mfma_f32_16x16x32_bf16 v[88:91], a[224:227], v[128:131], v[88:91]
  v_mfma_f32_16x16x32_bf16 v[92:95], a[240:243], v[128:131], v[92:95]
  v_mfma_f32_16x16x32_bf16 v[88:91], a[228:231], v[132:135], v[88:91]
  v_mfma_f32_16x16x32_bf16 v[92:95], a[244:247], v[132:135], v[92:95]
  v_mfma_f32_16x16x32_bf16 v[88:91], a[232:235], v[136:139], v[88:91]
  v_mfma_f32_16x16x32_bf16 v[92:95], a[248:251], v[136:139], v[92:95]
  v_mfma_f32_16x16x32_bf16 v[88:91], a[236:239], v[140:143], v[88:91]
  v_mfma_f32_16x16x32_bf16 v[92:95], a[252:255], v[140:143], v[92:95]
  v_add_u32 v80, s6, v80
  v_add_u32 v81, s7, v81
  v_perm_b32 v152, v81, v80, v30
  v_add_u32 v82, s78, v82
  v_add_u32 v83, s79, v83
  v_perm_b32 v153, v83, v82, v30
  v_add_u32 v84, s84, v84
  v_add_u32 v85, s85, v85
  v_perm_b32 v154, v85, v84, v30
  v_add_u32 v86, s86, v86
  v_add_u32 v87, s87, v87
  v_perm_b32 v155, v87, v86, v30
  s_cmp_ge_u32 s16, 8
  s_cbranch_scc1 L_nr_48
  s_cmp_lg_u32 s3, 0
  s_cbranch_scc1 L_nr_48
  v_mov_b32 v9, s13
  s_lshl_b32 s48, s17, 7
  s_add_u32 s48, s48, 12288
  s_mov_b64 s[44:45], exec
  s_mov_b64 exec, 1
  buffer_store_dword v9, v5, s[8:11], s48 offen sc1
  s_mov_b64 exec, s[44:45]
L_nr_48:
  v_add_u32 v88, s6, v88
  v_add_u32 v89, s7, v89
  v_perm_b32 v156, v89, v88, v30
  v_add_u32 v90, s78, v90
  v_add_u32 v91, s79, v91
  v_perm_b32 v157, v91, v90, v30
  v_add_u32 v92, s84, v92
  v_add_u32 v93, s85, v93
  v_perm_b32 v158, v93, v92, v30
  v_add_u32 v94, s86, v94
  v_add_u32 v95, s87, v95
  v_perm_b32 v159, v95, v94, v30
  v_mov_b32 v112, v152
  v_mov_b32 v113, v153
  v_mov_b32 v114, v154
  v_mov_b32 v115, v155
  v_mov_b32_dpp v152, v156 row_ror:8 row_mask:0xf bank_mask:0xc
  v_mov_b32_dpp v153, v157 row_ror:8 row_mask:0xf bank_mask:0xc
  v_mov_b32_dpp v154, v158 row_ror:8 row_mask:0xf bank_mask:0xc
  v_mov_b32_dpp v155, v159 row_ror:8 row_mask:0xf bank_mask:0xc
  v_mov_b32_dpp v156, v112 row_ror:8 row_mask:0xf bank_mask:0x3
  v_mov_b32_dpp v157, v113 row_ror:8 row_mask:0xf bank_mask:0x3
  v_mov_b32_dpp v158, v114 row_ror:8 row_mask:0xf bank_mask:0x3
  v_mov_b32_dpp v159, v115 row_ror:8 row_mask:0xf bank_mask:0x3
  v_bfi_b32 v152, s101, v56, v152
  v_bfi_b32 v153, s101, v57, v153
  v_bfi_b32 v154, s101, v58, v154
  v_bfi_b32 v155, s101, v59, v155
  v_bfi_b32 v156, s101, v56, v156
  v_bfi_b32 v157, s101, v57, v157
  v_bfi_b32 v158, s101, v58, v158
  v_bfi_b32 v159, s101, v59, v159
  buffer_store_dwordx4 v[152:155], v7, s[8:11], s61 offen offset:128 sc1
  buffer_store_dwordx4 v[156:159], v7, s[8:11], s62 offen offset:128 sc1
  s_waitcnt lgkmcnt(0)
  s_barrier
  s_cmp_eq_u32 s22, 1
  s_cbranch_scc1 L_G
  s_cmp_eq_u32 s22, 2
  s_cbranch_scc1 L_H
  s_cmp_eq_u32 s22, 3
  s_cbranch_scc1 L_END
  v_lshrrev_b32 v6, 3, v1
  v_mul_u32_u24 v6, 1280, v6
  v_and_b32 v7, 7, v1
  v_lshl_add_u32 v11, v7, 4, v6
  s_mul_i32 s49, s17, 655360
  s_mul_i32 s51, s3, 163840
  s_add_u32 s49, s49, s51
  s_lshl_b32 s51, s18, 7
  s_add_u32 s49, s49, s51
  s_lshl_b32 s51, s3, 14
  s_mov_b32 m0, s51
  s_add_u32 s51, s51, 1024
  buffer_load_dwordx4 v11, s[36:39], s49 offen nt lds
  s_add_u32 s49, s49, 10240
  s_mov_b32 m0, s51
  s_add_u32 s51, s51, 1024
  buffer_load_dwordx4 v11, s[36:39], s49 offen nt lds
  s_add_u32 s49, s49, 10240
  s_mov_b32 m0, s51
  s_add_u32 s51, s51, 1024
  buffer_load_dwordx4 v11, s[36:39], s49 offen nt lds
  s_add_u32 s49, s49, 10240
  s_mov_b32 m0, s51
  s_add_u32 s51, s51, 1024
  buffer_load_dwordx4 v11, s[36:39], s49 offen nt lds
  s_add_u32 s49, s49, 10240
  s_mov_b32 m0, s51
  s_add_u32 s51, s51, 1024
  buffer_load_dwordx4 v11, s[36:39], s49 offen nt lds
  s_add_u32 s49, s49, 10240
  s_mov_b32 m0, s51
  s_add_u32 s51, s51, 1024
  buffer_load_dwordx4 v11, s[36:39], s49 offen nt lds
  s_add_u32 s49, s49, 10240
  s_mov_b32 m0, s51
  s_add_u32 s51, s51, 1024
  buffer_load_dwordx4 v11, s[36:39], s49 offen nt lds
  s_add_u32 s49, s49, 10240
  s_mov_b32 m0, s51
  s_add_u32 s51, s51, 1024
  buffer_load_dwordx4 v11, s[36:39], s49 offen nt lds
  s_add_u32 s49, s49, 10240
  s_mov_b32 m0, s51
  s_add_u32 s51, s51, 1024
  buffer_load_dwordx4 v11, s[36:39], s49 offen nt lds
  s_add_u32 s49, s49, 10240
  s_mov_b32 m0, s51
  s_add_u32 s51, s51, 1024
  buffer_load_dwordx4 v11, s[36:39], s49 offen nt lds
  s_add_u32 s49, s49, 10240
  s_mov_b32 m0, s51
  s_add_u32 s51, s51, 1024
  buffer_load_dwordx4 v11, s[36:39], s49 offen nt lds
  s_add_u32 s49, s49, 10240
  s_mov_b32 m0, s51
  s_add_u32 s51, s51, 1024
  buffer_load_dwordx4 v11, s[36:39], s49 offen nt lds
  s_add_u32 s49, s49, 10240
  s_mov_b32 m0, s51
  s_add_u32 s51, s51, 1024
  buffer_load_dwordx4 v11, s[36:39], s49 offen nt lds
  s_add_u32 s49, s49, 10240
  s_mov_b32 m0, s51
  s_add_u32 s51, s51, 1024
  buffer_load_dwordx4 v11, s[36:39], s49 offen nt lds
  s_add_u32 s49, s49, 10240
  s_mov_b32 m0, s51
  s_add_u32 s51, s51, 1024
  buffer_load_dwordx4 v11, s[36:39], s49 offen nt lds
  s_add_u32 s49, s49, 10240
  s_mov_b32 m0, s51
  s_add_u32 s51, s51, 1024
  buffer_load_dwordx4 v11, s[36:39], s49 offen nt lds
  s_add_u32 s49, s49, 10240
  v_bfe_u32 v6, v0, 5, 2
  v_lshlrev_b32 v6, 12, v6
  v_lshrrev_b32 v7, 7, v0
  v_lshl_add_u32 v6, v7, 11, v6
  v_and_b32 v8, 31, v0
  v_lshl_add_u32 v14, v8, 4, v6
  s_lshl_b32 s60, s17, 14
  s_add_u32 s60, s60, 655360
  v_bfe_u32 v6, v0, 3, 4
  v_lshl_add_u32 v6, v7, 4, v6
  v_and_b32 v8, 3, v0
  v_lshl_add_u32 v6, v6, 2, v8
  v_lshlrev_b32 v6, 4, v6
  v_bfe_u32 v8, v0, 2, 1
  v_lshl_add_u32 v15, v8, 3, v6
  v_add_u32 v15, 118784, v15
  v_and_b32 v6, 1, v2
  v_lshlrev_b32 v6, 10, v6
  v_lshl_add_u32 v6, v3, 4, v6
  s_lshl_b32 s48, s3, 8
  s_add_u32 s48, s48, 118784
  v_add_u32 v16, s48, v6
  v_lshlrev_b32 v6, 8, v2
  v_lshl_add_u32 v6, v3, 4, v6
  s_lshl_b32 s48, s3, 9
  s_add_u32 s48, s48, 126976
  v_add_u32 v17, s48, v6
  v_cmp_gt_u32 s[46:47], 2, v2
  s_lshl_b32 s48, s3, 7
  s_add_u32 s48, s48, 126976
  v_lshlrev_b32 v18, 2, v1
  v_add_u32 v19, s48, v18
  s_lshr_b32 s48, s3, 1
  s_lshl_b32 s61, s17, 1
  s_add_u32 s61, s61, s48
  s_mul_i32 s61, s61, 2560
  s_lshl_b32 s62, s18, 8
  s_add_u32 s61, s61, s62
  s_and_b32 s48, s3, 1
  s_lshl_b32 s48, s48, 7
  s_add_u32 s61, s61, s48
  s_add_u32 s61, s61, 786432
  v_lshrrev_b32 v6, 2, v1
  v_lshlrev_b32 v6, 7, v6
  v_and_b32 v7, 3, v1
  v_lshl_add_u32 v6, v7, 3, v6
  s_lshl_b32 s48, s3, 14
  v_add_u32 v6, s48, v6
  s_waitcnt vmcnt(0)
  ds_read_b64_tr_b16 v[128:129], v6 offset:0
  ds_read_b64_tr_b16 v[130:131], v6 offset:2048
  ds_read_b64_tr_b16 v[132:133], v6 offset:32
  ds_read_b64_tr_b16 v[134:135], v6 offset:2080
  ds_read_b64_tr_b16 v[136:137], v6 offset:64
  ds_read_b64_tr_b16 v[138:139], v6 offset:2112
  ds_read_b64_tr_b16 v[140:141], v6 offset:96
  ds_read_b64_tr_b16 v[142:143], v6 offset:2144
  ds_read_b64_tr_b16 v[144:145], v6 offset:4096
  ds_read_b64_tr_b16 v[146:147], v6 offset:6144
  ds_read_b64_tr_b16 v[148:149], v6 offset:4128
  ds_read_b64_tr_b16 v[150:151], v6 offset:6176
  ds_read_b64_tr_b16 v[152:153], v6 offset:4160
  ds_read_b64_tr_b16 v[154:155], v6 offset:6208
  ds_read_b64_tr_b16 v[156:157], v6 offset:4192
  ds_read_b64_tr_b16 v[158:159], v6 offset:6240
  ds_read_b64_tr_b16 v[160:161], v6 offset:8192
  ds_read_b64_tr_b16 v[162:163], v6 offset:10240
  ds_read_b64_tr_b16 v[164:165], v6 offset:8224
  ds_read_b64_tr_b16 v[166:167], v6 offset:10272
  ds_read_b64_tr_b16 v[168:169], v6 offset:8256
  ds_read_b64_tr_b16 v[170:171], v6 offset:10304
  ds_read_b64_tr_b16 v[172:173], v6 offset:8288
  ds_read_b64_tr_b16 v[174:175], v6 offset:10336
  ds_read_b64_tr_b16 v[176:177], v6 offset:12288
  ds_read_b64_tr_b16 v[178:179], v6 offset:14336
  ds_read_b64_tr_b16 v[180:181], v6 offset:12320
  ds_read_b64_tr_b16 v[182:183], v6 offset:14368
  ds_read_b64_tr_b16 v[184:185], v6 offset:12352
  ds_read_b64_tr_b16 v[186:187], v6 offset:14400
  ds_read_b64_tr_b16 v[188:189], v6 offset:12384
  ds_read_b64_tr_b16 v[190:191], v6 offset:14432
  v_mov_b32 v64, 0
  v_mov_b32 v65, 0
  v_mov_b32 v66, 0
  v_mov_b32 v67, 0
  v_mov_b32 v68, 0
  v_mov_b32 v69, 0
  v_mov_b32 v70, 0
  v_mov_b32 v71, 0
  v_mov_b32 v72, 0
  v_mov_b32 v73, 0
  v_mov_b32 v74, 0
  v_mov_b32 v75, 0
  v_mov_b32 v76, 0
  v_mov_b32 v77, 0
  v_mov_b32 v78, 0
  v_mov_b32 v79, 0
  s_mov_b32 s48, 9216
  v_and_b32 v7, 7, v1
  v_lshlrev_b32 v7, 7, v7
L_db_49:
  buffer_load_dword v6, v7, s[8:11], s48 offen sc1
  s_waitcnt vmcnt(0)
  v_cmp_ne_u32 vcc, s13, v6
  s_nop 0
  s_cbranch_vccz L_dbd_50
  s_sleep 1
  s_add_u32 s15, s15, 1
  s_cmp_lt_u32 s15, 100000
  s_cbranch_scc1 L_db_49
L_dbd_50:
  buffer_load_dwordx4 v[32:35], v14, s[8:11], s60 offen sc1
  buffer_load_dwordx4 v[36:39], v14, s[8:11], s60 offen offset:512 sc1
  buffer_load_dwordx4 v[40:43], v14, s[8:11], s60 offen offset:1024 sc1
  buffer_load_dwordx4 v[44:47], v14, s[8:11], s60 offen offset:1536 sc1
  v_mov_b32 v6, 0
  s_waitcnt vmcnt(3)
  v_msad_u8 v6, v32, v4, v6
  v_msad_u8 v6, v33, v4, v6
  v_msad_u8 v6, v34, v4, v6
  v_msad_u8 v6, v35, v4, v6
  s_waitcnt vmcnt(2)
  v_msad_u8 v6, v36, v4, v6
  v_msad_u8 v6, v37, v4, v6
  v_msad_u8 v6, v38, v4, v6
  v_msad_u8 v6, v39, v4, v6
  s_waitcnt vmcnt(1)
  v_msad_u8 v6, v40, v4, v6
  v_msad_u8 v6, v41, v4, v6
  v_msad_u8 v6, v42, v4, v6
  v_msad_u8 v6, v43, v4, v6
  s_waitcnt vmcnt(0)
  v_msad_u8 v6, v44, v4, v6
  v_msad_u8 v6, v45, v4, v6
  v_msad_u8 v6, v46, v4, v6
  v_msad_u8 v6, v47, v4, v6
  v_cmp_ne_u32 vcc, 0, v6
  s_nop 0
  s_cbranch_vccz L_pld_51
L_pls_52:
  s_mov_b32 s100, 0
  v_mov_b32 v6, 0
  v_msad_u8 v6, v32, v4, v6
  v_msad_u8 v6, v33, v4, v6
  v_msad_u8 v6, v34, v4, v6
  v_msad_u8 v6, v35, v4, v6
  v_cmp_ne_u32 vcc, 0, v6
  s_nop 0
  s_cbranch_vccz L_plk_53
  buffer_load_dwordx4 v[32:35], v14, s[8:11], s60 offen sc1
  s_mov_b32 s100, 1
L_plk_53:
  v_mov_b32 v6, 0
  v_msad_u8 v6, v36, v4, v6
  v_msad_u8 v6, v37, v4, v6
  v_msad_u8 v6, v38, v4, v6
  v_msad_u8 v6, v39, v4, v6
  v_cmp_ne_u32 vcc, 0, v6
  s_nop 0
  s_cbranch_vccz L_plk_54
  buffer_load_dwordx4 v[36:39], v14, s[8:11], s60 offen offset:512 sc1
  s_mov_b32 s100, 1
L_plk_54:
  v_mov_b32 v6, 0
  v_msad_u8 v6, v40, v4, v6
  v_msad_u8 v6, v41, v4, v6
  v_msad_u8 v6, v42, v4, v6
  v_msad_u8 v6, v43, v4, v6
  v_cmp_ne_u32 vcc, 0, v6
  s_nop 0
  s_cbranch_vccz L_plk_55
  buffer_load_dwordx4 v[40:43], v14, s[8:11], s60 offen offset:1024 sc1
  s_mov_b32 s100, 1
L_plk_55:
  v_mov_b32 v6, 0
  v_msad_u8 v6, v44, v4, v6
  v_msad_u8 v6, v45, v4, v6
  v_msad_u8 v6, v46, v4, v6
  v_msad_u8 v6, v47, v4, v6
  v_cmp_ne_u32 vcc, 0, v6
  s_nop 0
  s_cbranch_vccz L_plk_56
  buffer_load_dwordx4 v[44:47], v14, s[8:11], s60 offen offset:1536 sc1
  s_mov_b32 s100, 1
L_plk_56:
  s_cmp_eq_u32 s100, 0
  s_cbranch_scc1 L_pld_51
  s_waitcnt vmcnt(0)
  s_add_u32 s15, s15, 1
  s_cmp_lt_u32 s15, 100000
  s_cbranch_scc1 L_pls_52
L_pld_51:
  v_add_f32 v32, v32, v36
  v_add_f32 v40, v40, v44
  v_add_f32 v32, v32, v40
  v_add_f32 v33, v33, v37
  v_add_f32 v41, v41, v45
  v_add_f32 v33, v33, v41
  v_add_f32 v34, v34, v38
  v_add_f32 v42, v42, v46
  v_add_f32 v34, v34, v42
  v_add_f32 v35, v35, v39
  v_add_f32 v43, v43, v47
  v_add_f32 v35, v35, v43
  v_cvt_pk_bf16_f32 v32, v32, v33
  v_cvt_pk_bf16_f32 v33, v34, v35
  ds_write_b64 v15, v[32:33]
  s_waitcnt lgkmcnt(0)
  s_barrier
  ds_read_b128 v[32:35], v16 offset:0
  ds_read_b128 v[36:39], v16 offset:64
  ds_read_b128 v[40:43], v16 offset:128
  ds_read_b128 v[44:47], v16 offset:192
  s_waitcnt lgkmcnt(3)
  v_mfma_f32_16x16x32_bf16 v[64:67], v[128:131], v[32:35], v[64:67]
  v_mfma_f32_16x16x32_bf16 v[68:71], v[132:135], v[32:35], v[68:71]
  v_mfma_f32_16x16x32_bf16 v[72:75], v[136:139], v[32:35], v[72:75]
  v_mfma_f32_16x16x32_bf16 v[76:79], v[140:143], v[32:35], v[76:79]
  s_waitcnt lgkmcnt(2)
  v_mfma_f32_16x16x32_bf16 v[64:67], v[144:147], v[36:39], v[64:67]
  v_mfma_f32_16x16x32_bf16 v[68:71], v[148:151], v[36:39], v[68:71]
  v_mfma_f32_16x16x32_bf16 v[72:75], v[152:155], v[36:39], v[72:75]
  v_mfma_f32_16x16x32_bf16 v[76:79], v[156:159], v[36:39], v[76:79]
  s_waitcnt lgkmcnt(1)
  v_mfma_f32_16x16x32_bf16 v[64:67], v[160:163], v[40:43], v[64:67]
  v_mfma_f32_16x16x32_bf16 v[68:71], v[164:167], v[40:43], v[68:71]
  v_mfma_f32_16x16x32_bf16 v[72:75], v[168:171], v[40:43], v[72:75]
  v_mfma_f32_16x16x32_bf16 v[76:79], v[172:175], v[40:43], v[76:79]
  s_waitcnt lgkmcnt(0)
  v_mfma_f32_16x16x32_bf16 v[64:67], v[176:179], v[44:47], v[64:67]
  v_mfma_f32_16x16x32_bf16 v[68:71], v[180:183], v[44:47], v[68:71]
  v_mfma_f32_16x16x32_bf16 v[72:75], v[184:187], v[44:47], v[72:75]
  v_mfma_f32_16x16x32_bf16 v[76:79], v[188:191], v[44:47], v[76:79]
  s_cmp_ge_u32 s16, 8
  s_cbranch_scc1 L_nr_57
  s_cmp_lg_u32 s3, 0
  s_cbranch_scc1 L_nr_57
  v_mov_b32 v6, s13
  s_lshl_b32 s48, s17, 7
  s_add_u32 s48, s48, 10240
  s_mov_b64 s[44:45], exec
  s_mov_b64 exec, 1
  buffer_store_dword v6, v5, s[8:11], s48 offen sc1
  s_mov_b64 exec, s[44:45]
L_nr_57:
  s_mov_b64 s[44:45], exec
  s_mov_b64 exec, s[46:47]
  s_nop 0
  ds_write_b128 v17, v[64:67] offset:0
  ds_write_b128 v17, v[68:71] offset:64
  ds_write_b128 v17, v[72:75] offset:128
  ds_write_b128 v17, v[76:79] offset:192
  s_mov_b64 exec, s[44:45]
  s_waitcnt lgkmcnt(0)
  s_barrier
  v_cmp_gt_u32 vcc, 32, v1
  s_nop 0
  s_and_saveexec_b64 s[44:45], vcc
  ds_read_b32 v32, v19 offset:0
  ds_read_b32 v33, v19 offset:512
  ds_read_b32 v34, v19 offset:1024
  ds_read_b32 v35, v19 offset:1536
  s_waitcnt lgkmcnt(0)
  v_add_f32 v32, v32, v33
  v_add_f32 v34, v34, v35
  v_add_f32 v32, v32, v34
  v_bfi_b32 v32, s14, v4, v32
  buffer_store_dword v32, v18, s[8:11], s61 offen sc1
  s_mov_b64 exec, s[44:45]
  s_endpgm
L_G:
  global_load_dwordx4 a[96:99], v[12:13], off nt
  v_add_co_u32 v12, vcc, 13824, v12
  s_nop 1
  v_addc_co_u32 v13, vcc, 0, v13, vcc
  global_load_dwordx4 a[100:103], v[12:13], off nt
  v_add_co_u32 v12, vcc, 13824, v12
  s_nop 1
  v_addc_co_u32 v13, vcc, 0, v13, vcc
  global_load_dwordx4 a[104:107], v[12:13], off nt
  v_add_co_u32 v12, vcc, 13824, v12
  s_nop 1
  v_addc_co_u32 v13, vcc, 0, v13, vcc
  global_load_dwordx4 a[108:111], v[12:13], off nt
  v_add_co_u32 v12, vcc, 13824, v12
  s_nop 1
  v_addc_co_u32 v13, vcc, 0, v13, vcc
  global_load_dwordx4 a[112:115], v[12:13], off nt
  v_add_co_u32 v12, vcc, 13824, v12
  s_nop 1
  v_addc_co_u32 v13, vcc, 0, v13, vcc
  global_load_dwordx4 a[116:119], v[12:13], off nt
  v_add_co_u32 v12, vcc, 13824, v12
  s_nop 1
  v_addc_co_u32 v13, vcc, 0, v13, vcc
  global_load_dwordx4 a[120:123], v[12:13], off nt
  v_add_co_u32 v12, vcc, 13824, v12
  s_nop 1
  v_addc_co_u32 v13, vcc, 0, v13, vcc
  global_load_dwordx4 a[124:127], v[12:13], off nt
  v_add_co_u32 v12, vcc, 13824, v12
  s_nop 1
  v_addc_co_u32 v13, vcc, 0, v13, vcc
  global_load_dwordx4 a[128:131], v[12:13], off nt
  v_add_co_u32 v12, vcc, 13824, v12
  s_nop 1
  v_addc_co_u32 v13, vcc, 0, v13, vcc
  global_load_dwordx4 a[132:135], v[12:13], off nt
  v_add_co_u32 v12, vcc, 13824, v12
  s_nop 1
  v_addc_co_u32 v13, vcc, 0, v13, vcc
  global_load_dwordx4 a[136:139], v[12:13], off nt
  v_add_co_u32 v12, vcc, 13824, v12
  s_nop 1
  v_addc_co_u32 v13, vcc, 0, v13, vcc
  global_load_dwordx4 a[140:143], v[12:13], off nt
  v_add_co_u32 v12, vcc, 13824, v12
  s_nop 1
  v_addc_co_u32 v13, vcc, 0, v13, vcc
  global_load_dwordx4 a[144:147], v[12:13], off nt
  v_add_co_u32 v12, vcc, 13824, v12
  s_nop 1
  v_addc_co_u32 v13, vcc, 0, v13, vcc
  global_load_dwordx4 a[148:151], v[12:13], off nt
  v_add_co_u32 v12, vcc, 13824, v12
  s_nop 1
  v_addc_co_u32 v13, vcc, 0, v13, vcc
  global_load_dwordx4 a[152:155], v[12:13], off nt
  v_add_co_u32 v12, vcc, 13824, v12
  s_nop 1
  v_addc_co_u32 v13, vcc, 0, v13, vcc
  global_load_dwordx4 a[156:159], v[12:13], off nt
  v_add_u32 v6, 0, v0
  v_lshlrev_b32 v14, 4, v6
  v_cmp_le_u32 vcc, 160, v6
  s_nop 1
  v_cndmask_b32 v17, 0, 1, vcc
  v_mul_u32_u24 v7, 7680, v17
  v_add_u32 v15, v14, v7
  v_mul_u32_u24 v7, 160, v17
  v_sub_u32 v6, v6, v7
  v_lshrrev_b32 v7, 3, v6
  v_mul_u32_u24 v8, 20, v17
  v_add_u32 v7, v7, v8
  v_and_b32 v8, 3, v6
  v_lshl_add_u32 v7, v7, 2, v8
  v_lshlrev_b32 v7, 4, v7
  v_bfe_u32 v8, v6, 2, 1
  v_lshl_add_u32 v16, v8, 3, v7
  v_add_u32 v16, 118784, v16
  v_add_u32 v6, 256, v0
  v_lshlrev_b32 v18, 4, v6
  v_cmp_le_u32 vcc, 160, v6
  s_nop 1
  v_cndmask_b32 v21, 0, 1, vcc
  v_mul_u32_u24 v7, 7680, v21
  v_add_u32 v19, v18, v7
  v_mul_u32_u24 v7, 160, v21
  v_sub_u32 v6, v6, v7
  v_lshrrev_b32 v7, 3, v6
  v_mul_u32_u24 v8, 20, v21
  v_add_u32 v7, v7, v8
  v_and_b32 v8, 3, v6
  v_lshl_add_u32 v7, v7, 2, v8
  v_lshlrev_b32 v7, 4, v7
  v_bfe_u32 v8, v6, 2, 1
  v_lshl_add_u32 v20, v8, 3, v7
  v_add_u32 v20, 118784, v20
  v_and_b32 v6, 1, v2
  v_mul_u32_u24 v6, 1280, v6
  v_lshl_add_u32 v6, v3, 4, v6
  s_mul_i32 s48, s3, 320
  s_add_u32 s48, s48, 118784
  v_add_u32 v22, s48, v6
  v_lshlrev_b32 v6, 9, v2
  v_lshl_add_u32 v6, v3, 4, v6
  s_lshl_b32 s48, s3, 10
  s_add_u32 s48, s48, 126976
  v_add_u32 v23, s48, v6
  v_cmp_gt_u32 s[46:47], 2, v2
  v_mul_u32_u24 v6, 288, v3
  v_lshl_add_u32 v6, v2, 4, v6
  s_mul_i32 s48, s3, 27648
  v_add_u32 v24, s48, v6
  v_lshrrev_b32 v6, 2, v1
  v_mul_u32_u24 v6, 288, v6
  v_and_b32 v7, 3, v1
  v_lshl_add_u32 v6, v7, 3, v6
  v_add_u32 v25, s48, v6
  ds_write_b128 v24, a[0:3] offset:0
  ds_write_b128 v24, a[4:7] offset:1152
  ds_write_b128 v24, a[8:11] offset:2304
  ds_write_b128 v24, a[12:15] offset:3456
  ds_write_b128 v24, a[16:19] offset:4608
  ds_write_b128 v24, a[20:23] offset:5760
  ds_write_b128 v24, a[24:27] offset:6912
  ds_write_b128 v24, a[28:31] offset:8064
  ds_write_b128 v24, a[32:35] offset:9216
  ds_write_b128 v24, a[36:39] offset:10368
  ds_write_b128 v24, a[40:43] offset:11520
  ds_write_b128 v24, a[44:47] offset:12672
  ds_write_b128 v24, a[48:51] offset:13824
  ds_write_b128 v24, a[52:55] offset:14976
  ds_write_b128 v24, a[56:59] offset:16128
  ds_write_b128 v24, a[60:63] offset:17280
  ds_write_b128 v24, a[64:67] offset:18432
  ds_write_b128 v24, a[68:71] offset:19584
  ds_write_b128 v24, a[72:75] offset:20736
  ds_write_b128 v24, a[76:79] offset:21888
  ds_write_b128 v24, a[80:83] offset:23040
  ds_write_b128 v24, a[84:87] offset:24192
  ds_write_b128 v24, a[88:91] offset:25344
  ds_write_b128 v24, a[92:95] offset:26496
  s_waitcnt lgkmcnt(0)
  ds_read_b64_tr_b16 a[0:1], v25 offset:0
  ds_read_b64_tr_b16 a[2:3], v25 offset:4608
  ds_read_b64_tr_b16 a[4:5], v25 offset:32
  ds_read_b64_tr_b16 a[6:7], v25 offset:4640
  ds_read_b64_tr_b16 a[8:9], v25 offset:64
  ds_read_b64_tr_b16 a[10:11], v25 offset:4672
  ds_read_b64_tr_b16 a[12:13], v25 offset:96
  ds_read_b64_tr_b16 a[14:15], v25 offset:4704
  ds_read_b64_tr_b16 a[16:17], v25 offset:128
  ds_read_b64_tr_b16 a[18:19], v25 offset:4736
  ds_read_b64_tr_b16 a[20:21], v25 offset:160
  ds_read_b64_tr_b16 a[22:23], v25 offset:4768
  ds_read_b64_tr_b16 a[24:25], v25 offset:192
  ds_read_b64_tr_b16 a[26:27], v25 offset:4800
  ds_read_b64_tr_b16 a[28:29], v25 offset:224
  ds_read_b64_tr_b16 a[30:31], v25 offset:4832
  ds_read_b64_tr_b16 a[32:33], v25 offset:9216
  ds_read_b64_tr_b16 a[34:35], v25 offset:13824
  ds_read_b64_tr_b16 a[36:37], v25 offset:9248
  ds_read_b64_tr_b16 a[38:39], v25 offset:13856
  ds_read_b64_tr_b16 a[40:41], v25 offset:9280
  ds_read_b64_tr_b16 a[42:43], v25 offset:13888
  ds_read_b64_tr_b16 a[44:45], v25 offset:9312
  ds_read_b64_tr_b16 a[46:47], v25 offset:13920
  ds_read_b64_tr_b16 a[48:49], v25 offset:9344
  ds_read_b64_tr_b16 a[50:51], v25 offset:13952
  ds_read_b64_tr_b16 a[52:53], v25 offset:9376
  ds_read_b64_tr_b16 a[54:55], v25 offset:13984
  ds_read_b64_tr_b16 a[56:57], v25 offset:9408
  ds_read_b64_tr_b16 a[58:59], v25 offset:14016
  ds_read_b64_tr_b16 a[60:61], v25 offset:9440
  ds_read_b64_tr_b16 a[62:63], v25 offset:14048
  ds_read_b64_tr_b16 a[64:65], v25 offset:18432
  ds_read_b64_tr_b16 a[66:67], v25 offset:23040
  ds_read_b64_tr_b16 a[68:69], v25 offset:18464
  ds_read_b64_tr_b16 a[70:71], v25 offset:23072
  ds_read_b64_tr_b16 a[72:73], v25 offset:18496
  ds_read_b64_tr_b16 a[74:75], v25 offset:23104
  ds_read_b64_tr_b16 a[76:77], v25 offset:18528
  ds_read_b64_tr_b16 a[78:79], v25 offset:23136
  ds_read_b64_tr_b16 a[80:81], v25 offset:18560
  ds_read_b64_tr_b16 a[82:83], v25 offset:23168
  ds_read_b64_tr_b16 a[84:85], v25 offset:18592
  ds_read_b64_tr_b16 a[86:87], v25 offset:23200
  ds_read_b64_tr_b16 a[88:89], v25 offset:18624
  ds_read_b64_tr_b16 a[90:91], v25 offset:23232
  ds_read_b64_tr_b16 a[92:93], v25 offset:18656
  ds_read_b64_tr_b16 a[94:95], v25 offset:23264
  s_waitcnt lgkmcnt(0)
  s_mov_b32 s60, 131072
  s_mov_b32 s61, 151552
  s_mov_b32 s62, 136192
  s_mov_b32 s63, 156672
  v_lshrrev_b32 v6, 1, v14
  buffer_load_dwordx2 v[48:49], v6, s[40:43], 0 offen
  buffer_load_dwordx4 v[36:39], v15, s[8:11], s60 offen sc1
  buffer_load_dwordx4 v[40:43], v15, s[8:11], s60 offen offset:2560 sc1
  buffer_load_dwordx4 v[44:47], v15, s[8:11], s62 offen sc1
  buffer_load_dwordx4 v[96:99], v15, s[8:11], s61 offen sc1
  buffer_load_dwordx4 v[100:103], v15, s[8:11], s61 offen offset:2560 sc1
  buffer_load_dwordx4 v[104:107], v15, s[8:11], s63 offen sc1
  v_mov_b32 v6, 0
  s_waitcnt vmcnt(5)
  v_msad_u8 v6, v36, v4, v6
  v_msad_u8 v6, v37, v4, v6
  v_msad_u8 v6, v38, v4, v6
  v_msad_u8 v6, v39, v4, v6
  s_waitcnt vmcnt(4)
  v_msad_u8 v6, v40, v4, v6
  v_msad_u8 v6, v41, v4, v6
  v_msad_u8 v6, v42, v4, v6
  v_msad_u8 v6, v43, v4, v6
  s_waitcnt vmcnt(3)
  v_msad_u8 v6, v44, v4, v6
  v_msad_u8 v6, v45, v4, v6
  v_msad_u8 v6, v46, v4, v6
  v_msad_u8 v6, v47, v4, v6
  s_waitcnt vmcnt(2)
  v_msad_u8 v6, v96, v4, v6
  v_msad_u8 v6, v97, v4, v6
  v_msad_u8 v6, v98, v4, v6
  v_msad_u8 v6, v99, v4, v6
  s_waitcnt vmcnt(1)
  v_msad_u8 v6, v100, v4, v6
  v_msad_u8 v6, v101, v4, v6
  v_msad_u8 v6, v102, v4, v6
  v_msad_u8 v6, v103, v4, v6
  s_waitcnt vmcnt(0)
  v_msad_u8 v6, v104, v4, v6
  v_msad_u8 v6, v105, v4, v6
  v_msad_u8 v6, v106, v4, v6
  v_msad_u8 v6, v107, v4, v6
  v_cmp_ne_u32 vcc, 0, v6
  s_nop 0
  s_cbranch_vccz L_pld_58
L_pls_59:
  s_mov_b32 s100, 0
  v_mov_b32 v6, 0
  v_msad_u8 v6, v36, v4, v6
  v_msad_u8 v6, v37, v4, v6
  v_msad_u8 v6, v38, v4, v6
  v_msad_u8 v6, v39, v4, v6
  v_cmp_ne_u32 vcc, 0, v6
  s_nop 0
  s_cbranch_vccz L_plk_60
  buffer_load_dwordx4 v[36:39], v15, s[8:11], s60 offen sc1
  s_mov_b32 s100, 1
L_plk_60:
  v_mov_b32 v6, 0
  v_msad_u8 v6, v40, v4, v6
  v_msad_u8 v6, v41, v4, v6
  v_msad_u8 v6, v42, v4, v6
  v_msad_u8 v6, v43, v4, v6
  v_cmp_ne_u32 vcc, 0, v6
  s_nop 0
  s_cbranch_vccz L_plk_61
  buffer_load_dwordx4 v[40:43], v15, s[8:11], s60 offen offset:2560 sc1
  s_mov_b32 s100, 1
L_plk_61:
  v_mov_b32 v6, 0
  v_msad_u8 v6, v44, v4, v6
  v_msad_u8 v6, v45, v4, v6
  v_msad_u8 v6, v46, v4, v6
  v_msad_u8 v6, v47, v4, v6
  v_cmp_ne_u32 vcc, 0, v6
  s_nop 0
  s_cbranch_vccz L_plk_62
  buffer_load_dwordx4 v[44:47], v15, s[8:11], s62 offen sc1
  s_mov_b32 s100, 1
L_plk_62:
  v_mov_b32 v6, 0
  v_msad_u8 v6, v96, v4, v6
  v_msad_u8 v6, v97, v4, v6
  v_msad_u8 v6, v98, v4, v6
  v_msad_u8 v6, v99, v4, v6
  v_cmp_ne_u32 vcc, 0, v6
  s_nop 0
  s_cbranch_vccz L_plk_63
  buffer_load_dwordx4 v[96:99], v15, s[8:11], s61 offen sc1
  s_mov_b32 s100, 1
L_plk_63:
  v_mov_b32 v6, 0
  v_msad_u8 v6, v100, v4, v6
  v_msad_u8 v6, v101, v4, v6
  v_msad_u8 v6, v102, v4, v6
  v_msad_u8 v6, v103, v4, v6
  v_cmp_ne_u32 vcc, 0, v6
  s_nop 0
  s_cbranch_vccz L_plk_64
  buffer_load_dwordx4 v[100:103], v15, s[8:11], s61 offen offset:2560 sc1
  s_mov_b32 s100, 1
L_plk_64:
  v_mov_b32 v6, 0
  v_msad_u8 v6, v104, v4, v6
  v_msad_u8 v6, v105, v4, v6
  v_msad_u8 v6, v106, v4, v6
  v_msad_u8 v6, v107, v4, v6
  v_cmp_ne_u32 vcc, 0, v6
  s_nop 0
  s_cbranch_vccz L_plk_65
  buffer_load_dwordx4 v[104:107], v15, s[8:11], s63 offen sc1
  s_mov_b32 s100, 1
L_plk_65:
  s_cmp_eq_u32 s100, 0
  s_cbranch_scc1 L_pld_58
  s_waitcnt vmcnt(0)
  s_add_u32 s15, s15, 1
  s_cmp_lt_u32 s15, 100000
  s_cbranch_scc1 L_pls_59
L_pld_58:
  v_add_f32 v36, v36, v96
  v_cvt_pk_bf16_f32 v36, v36, v36
  v_and_b32 v36, 0xffff0000, v36
  v_add_f32 v37, v37, v97
  v_cvt_pk_bf16_f32 v37, v37, v37
  v_and_b32 v37, 0xffff0000, v37
  v_add_f32 v38, v38, v98
  v_cvt_pk_bf16_f32 v38, v38, v38
  v_and_b32 v38, 0xffff0000, v38
  v_add_f32 v39, v39, v99
  v_cvt_pk_bf16_f32 v39, v39, v39
  v_and_b32 v39, 0xffff0000, v39
  v_add_f32 v40, v40, v100
  v_cvt_pk_bf16_f32 v40, v40, v40
  v_and_b32 v40, 0xffff0000, v40
  v_add_f32 v41, v41, v101
  v_cvt_pk_bf16_f32 v41, v41, v41
  v_and_b32 v41, 0xffff0000, v41
  v_add_f32 v42, v42, v102
  v_cvt_pk_bf16_f32 v42, v42, v42
  v_and_b32 v42, 0xffff0000, v42
  v_add_f32 v43, v43, v103
  v_cvt_pk_bf16_f32 v43, v43, v43
  v_and_b32 v43, 0xffff0000, v43
  v_add_f32 v44, v44, v104
  v_cvt_pk_bf16_f32 v44, v44, v44
  v_and_b32 v44, 0xffff0000, v44
  v_add_f32 v45, v45, v105
  v_cvt_pk_bf16_f32 v45, v45, v45
  v_and_b32 v45, 0xffff0000, v45
  v_add_f32 v46, v46, v106
  v_cvt_pk_bf16_f32 v46, v46, v46
  v_and_b32 v46, 0xffff0000, v46
  v_add_f32 v47, v47, v107
  v_cvt_pk_bf16_f32 v47, v47, v47
  v_and_b32 v47, 0xffff0000, v47
  v_lshlrev_b32 v32, 16, v48
  v_and_b32 v33, 0xffff0000, v48
  v_lshlrev_b32 v34, 16, v49
  v_and_b32 v35, 0xffff0000, v49
  v_add_f32 v44, 1.0, v44
  v_cvt_pk_bf16_f32 v44, v44, v44
  v_and_b32 v44, 0xffff0000, v44
  v_add_f32 v45, 1.0, v45
  v_cvt_pk_bf16_f32 v45, v45, v45
  v_and_b32 v45, 0xffff0000, v45
  v_add_f32 v46, 1.0, v46
  v_cvt_pk_bf16_f32 v46, v46, v46
  v_and_b32 v46, 0xffff0000, v46
  v_add_f32 v47, 1.0, v47
  v_cvt_pk_bf16_f32 v47, v47, v47
  v_and_b32 v47, 0xffff0000, v47
  s_cmp_lg_u32 s3, 0
  s_cbranch_scc1 L_sk_66
  v_lshrrev_b32 v6, 1, v18
  buffer_load_dwordx2 v[80:81], v6, s[40:43], 0 offen
  buffer_load_dwordx4 v[68:71], v19, s[8:11], s60 offen sc1
  buffer_load_dwordx4 v[72:75], v19, s[8:11], s60 offen offset:2560 sc1
  buffer_load_dwordx4 v[76:79], v19, s[8:11], s62 offen sc1
  buffer_load_dwordx4 v[108:111], v19, s[8:11], s61 offen sc1
  buffer_load_dwordx4 v[112:115], v19, s[8:11], s61 offen offset:2560 sc1
  buffer_load_dwordx4 v[116:119], v19, s[8:11], s63 offen sc1
  v_mov_b32 v6, 0
  s_waitcnt vmcnt(5)
  v_msad_u8 v6, v68, v4, v6
  v_msad_u8 v6, v69, v4, v6
  v_msad_u8 v6, v70, v4, v6
  v_msad_u8 v6, v71, v4, v6
  s_waitcnt vmcnt(4)
  v_msad_u8 v6, v72, v4, v6
  v_msad_u8 v6, v73, v4, v6
  v_msad_u8 v6, v74, v4, v6
  v_msad_u8 v6, v75, v4, v6
  s_waitcnt vmcnt(3)
  v_msad_u8 v6, v76, v4, v6
  v_msad_u8 v6, v77, v4, v6
  v_msad_u8 v6, v78, v4, v6
  v_msad_u8 v6, v79, v4, v6
  s_waitcnt vmcnt(2)
  v_msad_u8 v6, v108, v4, v6
  v_msad_u8 v6, v109, v4, v6
  v_msad_u8 v6, v110, v4, v6
  v_msad_u8 v6, v111, v4, v6
  s_waitcnt vmcnt(1)
  v_msad_u8 v6, v112, v4, v6
  v_msad_u8 v6, v113, v4, v6
  v_msad_u8 v6, v114, v4, v6
  v_msad_u8 v6, v115, v4, v6
  s_waitcnt vmcnt(0)
  v_msad_u8 v6, v116, v4, v6
  v_msad_u8 v6, v117, v4, v6
  v_msad_u8 v6, v118, v4, v6
  v_msad_u8 v6, v119, v4, v6
  v_cmp_ne_u32 vcc, 0, v6
  s_nop 0
  s_cbranch_vccz L_pld_67
L_pls_68:
  s_mov_b32 s100, 0
  v_mov_b32 v6, 0
  v_msad_u8 v6, v68, v4, v6
  v_msad_u8 v6, v69, v4, v6
  v_msad_u8 v6, v70, v4, v6
  v_msad_u8 v6, v71, v4, v6
  v_cmp_ne_u32 vcc, 0, v6
  s_nop 0
  s_cbranch_vccz L_plk_69
  buffer_load_dwordx4 v[68:71], v19, s[8:11], s60 offen sc1
  s_mov_b32 s100, 1
L_plk_69:
  v_mov_b32 v6, 0
  v_msad_u8 v6, v72, v4, v6
  v_msad_u8 v6, v73, v4, v6
  v_msad_u8 v6, v74, v4, v6
  v_msad_u8 v6, v75, v4, v6
  v_cmp_ne_u32 vcc, 0, v6
  s_nop 0
  s_cbranch_vccz L_plk_70
  buffer_load_dwordx4 v[72:75], v19, s[8:11], s60 offen offset:2560 sc1
  s_mov_b32 s100, 1
L_plk_70:
  v_mov_b32 v6, 0
  v_msad_u8 v6, v76, v4, v6
  v_msad_u8 v6, v77, v4, v6
  v_msad_u8 v6, v78, v4, v6
  v_msad_u8 v6, v79, v4, v6
  v_cmp_ne_u32 vcc, 0, v6
  s_nop 0
  s_cbranch_vccz L_plk_71
  buffer_load_dwordx4 v[76:79], v19, s[8:11], s62 offen sc1
  s_mov_b32 s100, 1
L_plk_71:
  v_mov_b32 v6, 0
  v_msad_u8 v6, v108, v4, v6
  v_msad_u8 v6, v109, v4, v6
  v_msad_u8 v6, v110, v4, v6
  v_msad_u8 v6, v111, v4, v6
  v_cmp_ne_u32 vcc, 0, v6
  s_nop 0
  s_cbranch_vccz L_plk_72
  buffer_load_dwordx4 v[108:111], v19, s[8:11], s61 offen sc1
  s_mov_b32 s100, 1
L_plk_72:
  v_mov_b32 v6, 0
  v_msad_u8 v6, v112, v4, v6
  v_msad_u8 v6, v113, v4, v6
  v_msad_u8 v6, v114, v4, v6
  v_msad_u8 v6, v115, v4, v6
  v_cmp_ne_u32 vcc, 0, v6
  s_nop 0
  s_cbranch_vccz L_plk_73
  buffer_load_dwordx4 v[112:115], v19, s[8:11], s61 offen offset:2560 sc1
  s_mov_b32 s100, 1
L_plk_73:
  v_mov_b32 v6, 0
  v_msad_u8 v6, v116, v4, v6
  v_msad_u8 v6, v117, v4, v6
  v_msad_u8 v6, v118, v4, v6
  v_msad_u8 v6, v119, v4, v6
  v_cmp_ne_u32 vcc, 0, v6
  s_nop 0
  s_cbranch_vccz L_plk_74
  buffer_load_dwordx4 v[116:119], v19, s[8:11], s63 offen sc1
  s_mov_b32 s100, 1
L_plk_74:
  s_cmp_eq_u32 s100, 0
  s_cbranch_scc1 L_pld_67
  s_waitcnt vmcnt(0)
  s_add_u32 s15, s15, 1
  s_cmp_lt_u32 s15, 100000
  s_cbranch_scc1 L_pls_68
L_pld_67:
  v_add_f32 v68, v68, v108
  v_cvt_pk_bf16_f32 v68, v68, v68
  v_and_b32 v68, 0xffff0000, v68
  v_add_f32 v69, v69, v109
  v_cvt_pk_bf16_f32 v69, v69, v69
  v_and_b32 v69, 0xffff0000, v69
  v_add_f32 v70, v70, v110
  v_cvt_pk_bf16_f32 v70, v70, v70
  v_and_b32 v70, 0xffff0000, v70
  v_add_f32 v71, v71, v111
  v_cvt_pk_bf16_f32 v71, v71, v71
  v_and_b32 v71, 0xffff0000, v71
  v_add_f32 v72, v72, v112
  v_cvt_pk_bf16_f32 v72, v72, v72
  v_and_b32 v72, 0xffff0000, v72
  v_add_f32 v73, v73, v113
  v_cvt_pk_bf16_f32 v73, v73, v73
  v_and_b32 v73, 0xffff0000, v73
  v_add_f32 v74, v74, v114
  v_cvt_pk_bf16_f32 v74, v74, v74
  v_and_b32 v74, 0xffff0000, v74
  v_add_f32 v75, v75, v115
  v_cvt_pk_bf16_f32 v75, v75, v75
  v_and_b32 v75, 0xffff0000, v75
  v_add_f32 v76, v76, v116
  v_cvt_pk_bf16_f32 v76, v76, v76
  v_and_b32 v76, 0xffff0000, v76
  v_add_f32 v77, v77, v117
  v_cvt_pk_bf16_f32 v77, v77, v77
  v_and_b32 v77, 0xffff0000, v77
  v_add_f32 v78, v78, v118
  v_cvt_pk_bf16_f32 v78, v78, v78
  v_and_b32 v78, 0xffff0000, v78
  v_add_f32 v79, v79, v119
  v_cvt_pk_bf16_f32 v79, v79, v79
  v_and_b32 v79, 0xffff0000, v79
  v_lshlrev_b32 v64, 16, v80
  v_and_b32 v65, 0xffff0000, v80
  v_lshlrev_b32 v66, 16, v81
  v_and_b32 v67, 0xffff0000, v81
  v_add_f32 v76, 1.0, v76
  v_cvt_pk_bf16_f32 v76, v76, v76
  v_and_b32 v76, 0xffff0000, v76
  v_add_f32 v77, 1.0, v77
  v_cvt_pk_bf16_f32 v77, v77, v77
  v_and_b32 v77, 0xffff0000, v77
  v_add_f32 v78, 1.0, v78
  v_cvt_pk_bf16_f32 v78, v78, v78
  v_and_b32 v78, 0xffff0000, v78
  v_add_f32 v79, 1.0, v79
  v_cvt_pk_bf16_f32 v79, v79, v79
  v_and_b32 v79, 0xffff0000, v79
L_sk_66:
  s_waitcnt vmcnt(0)
  ds_write_b128 v24, a[96:99] offset:0
  ds_write_b128 v24, a[100:103] offset:1152
  ds_write_b128 v24, a[104:107] offset:2304
  ds_write_b128 v24, a[108:111] offset:3456
  ds_write_b128 v24, a[112:115] offset:4608
  ds_write_b128 v24, a[116:119] offset:5760
  ds_write_b128 v24, a[120:123] offset:6912
  ds_write_b128 v24, a[124:127] offset:8064
  ds_write_b128 v24, a[128:131] offset:9216
  ds_write_b128 v24, a[132:135] offset:10368
  ds_write_b128 v24, a[136:139] offset:11520
  ds_write_b128 v24, a[140:143] offset:12672
  ds_write_b128 v24, a[144:147] offset:13824
  ds_write_b128 v24, a[148:151] offset:14976
  ds_write_b128 v24, a[152:155] offset:16128
  ds_write_b128 v24, a[156:159] offset:17280
  s_waitcnt lgkmcnt(0)
  ds_read_b64_tr_b16 a[96:97], v25 offset:0
  ds_read_b64_tr_b16 a[98:99], v25 offset:4608
  ds_read_b64_tr_b16 a[100:101], v25 offset:32
  ds_read_b64_tr_b16 a[102:103], v25 offset:4640
  ds_read_b64_tr_b16 a[104:105], v25 offset:64
  ds_read_b64_tr_b16 a[106:107], v25 offset:4672
  ds_read_b64_tr_b16 a[108:109], v25 offset:96
  ds_read_b64_tr_b16 a[110:111], v25 offset:4704
  ds_read_b64_tr_b16 a[112:113], v25 offset:128
  ds_read_b64_tr_b16 a[114:115], v25 offset:4736
  ds_read_b64_tr_b16 a[116:117], v25 offset:160
  ds_read_b64_tr_b16 a[118:119], v25 offset:4768
  ds_read_b64_tr_b16 a[120:121], v25 offset:192
  ds_read_b64_tr_b16 a[122:123], v25 offset:4800
  ds_read_b64_tr_b16 a[124:125], v25 offset:224
  ds_read_b64_tr_b16 a[126:127], v25 offset:4832
  ds_read_b64_tr_b16 a[128:129], v25 offset:9216
  ds_read_b64_tr_b16 a[130:131], v25 offset:13824
  ds_read_b64_tr_b16 a[132:133], v25 offset:9248
  ds_read_b64_tr_b16 a[134:135], v25 offset:13856
  ds_read_b64_tr_b16 a[136:137], v25 offset:9280
  ds_read_b64_tr_b16 a[138:139], v25 offset:13888
  ds_read_b64_tr_b16 a[140:141], v25 offset:9312
  ds_read_b64_tr_b16 a[142:143], v25 offset:13920
  ds_read_b64_tr_b16 a[144:145], v25 offset:9344
  ds_read_b64_tr_b16 a[146:147], v25 offset:13952
  ds_read_b64_tr_b16 a[148:149], v25 offset:9376
  ds_read_b64_tr_b16 a[150:151], v25 offset:13984
  ds_read_b64_tr_b16 a[152:153], v25 offset:9408
  ds_read_b64_tr_b16 a[154:155], v25 offset:14016
  ds_read_b64_tr_b16 a[156:157], v25 offset:9440
  ds_read_b64_tr_b16 a[158:159], v25 offset:14048
  s_waitcnt lgkmcnt(0)
  s_mov_b32 s80, 786432
  s_mov_b32 s81, 791552
  s_mov_b32 s82, 796672
  s_mov_b32 s83, 801792
  s_mov_b32 s84, 806912
  s_mov_b32 s85, 812032
  s_mov_b32 s86, 817152
  s_mov_b32 s87, 822272
  v_mov_b32 v120, 0
  v_mov_b32 v121, 0
  v_mov_b32 v122, 0
  v_mov_b32 v123, 0
  s_mov_b32 s48, 10240
  v_and_b32 v7, 7, v1
  v_lshlrev_b32 v7, 7, v7
L_db_75:
  buffer_load_dword v6, v7, s[8:11], s48 offen sc1
  s_waitcnt vmcnt(0)
  v_cmp_ne_u32 vcc, s13, v6
  s_nop 0
  s_cbranch_vccz L_dbd_76
  s_sleep 1
  s_add_u32 s15, s15, 1
  s_cmp_lt_u32 s15, 100000
  s_cbranch_scc1 L_db_75
L_dbd_76:
  s_cmp_eq_u32 s3, 0
  s_cbranch_scc1 L_w0_77
  buffer_load_dwordx4 v[128:131], v14, s[8:11], s80 offen sc1
  buffer_load_dwordx4 v[132:135], v14, s[8:11], s81 offen sc1
  buffer_load_dwordx4 v[136:139], v14, s[8:11], s82 offen sc1
  buffer_load_dwordx4 v[140:143], v14, s[8:11], s83 offen sc1
  buffer_load_dwordx4 v[144:147], v14, s[8:11], s84 offen sc1
  buffer_load_dwordx4 v[148:151], v14, s[8:11], s85 offen sc1
  buffer_load_dwordx4 v[152:155], v14, s[8:11], s86 offen sc1
  buffer_load_dwordx4 v[156:159], v14, s[8:11], s87 offen sc1
  v_mov_b32 v6, 0
  s_waitcnt vmcnt(7)
  v_msad_u8 v6, v128, v4, v6
  v_msad_u8 v6, v129, v4, v6
  v_msad_u8 v6, v130, v4, v6
  v_msad_u8 v6, v131, v4, v6
  s_waitcnt vmcnt(6)
  v_msad_u8 v6, v132, v4, v6
  v_msad_u8 v6, v133, v4, v6
  v_msad_u8 v6, v134, v4, v6
  v_msad_u8 v6, v135, v4, v6
  s_waitcnt vmcnt(5)
  v_msad_u8 v6, v136, v4, v6
  v_msad_u8 v6, v137, v4, v6
  v_msad_u8 v6, v138, v4, v6
  v_msad_u8 v6, v139, v4, v6
  s_waitcnt vmcnt(4)
  v_msad_u8 v6, v140, v4, v6
  v_msad_u8 v6, v141, v4, v6
  v_msad_u8 v6, v142, v4, v6
  v_msad_u8 v6, v143, v4, v6
  s_waitcnt vmcnt(3)
  v_msad_u8 v6, v144, v4, v6
  v_msad_u8 v6, v145, v4, v6
  v_msad_u8 v6, v146, v4, v6
  v_msad_u8 v6, v147, v4, v6
  s_waitcnt vmcnt(2)
  v_msad_u8 v6, v148, v4, v6
  v_msad_u8 v6, v149, v4, v6
  v_msad_u8 v6, v150, v4, v6
  v_msad_u8 v6, v151, v4, v6
  s_waitcnt vmcnt(1)
  v_msad_u8 v6, v152, v4, v6
  v_msad_u8 v6, v153, v4, v6
  v_msad_u8 v6, v154, v4, v6
  v_msad_u8 v6, v155, v4, v6
  s_waitcnt vmcnt(0)
  v_msad_u8 v6, v156, v4, v6
  v_msad_u8 v6, v157, v4, v6
  v_msad_u8 v6, v158, v4, v6
  v_msad_u8 v6, v159, v4, v6
  v_cmp_ne_u32 vcc, 0, v6
  s_nop 0
  s_cbranch_vccz L_pld_79
L_pls_80:
  s_mov_b32 s100, 0
  v_mov_b32 v6, 0
  v_msad_u8 v6, v128, v4, v6
  v_msad_u8 v6, v129, v4, v6
  v_msad_u8 v6, v130, v4, v6
  v_msad_u8 v6, v131, v4, v6
  v_cmp_ne_u32 vcc, 0, v6
  s_nop 0
  s_cbranch_vccz L_plk_81
  buffer_load_dwordx4 v[128:131], v14, s[8:11], s80 offen sc1
  s_mov_b32 s100, 1
L_plk_81:
  v_mov_b32 v6, 0
  v_msad_u8 v6, v132, v4, v6
  v_msad_u8 v6, v133, v4, v6
  v_msad_u8 v6, v134, v4, v6
  v_msad_u8 v6, v135, v4, v6
  v_cmp_ne_u32 vcc, 0, v6
  s_nop 0
  s_cbranch_vccz L_plk_82
  buffer_load_dwordx4 v[132:135], v14, s[8:11], s81 offen sc1
  s_mov_b32 s100, 1
L_plk_82:
  v_mov_b32 v6, 0
  v_msad_u8 v6, v136, v4, v6
  v_msad_u8 v6, v137, v4, v6
  v_msad_u8 v6, v138, v4, v6
  v_msad_u8 v6, v139, v4, v6
  v_cmp_ne_u32 vcc, 0, v6
  s_nop 0
  s_cbranch_vccz L_plk_83
  buffer_load_dwordx4 v[136:139], v14, s[8:11], s82 offen sc1
  s_mov_b32 s100, 1
L_plk_83:
  v_mov_b32 v6, 0
  v_msad_u8 v6, v140, v4, v6
  v_msad_u8 v6, v141, v4, v6
  v_msad_u8 v6, v142, v4, v6
  v_msad_u8 v6, v143, v4, v6
  v_cmp_ne_u32 vcc, 0, v6
  s_nop 0
  s_cbranch_vccz L_plk_84
  buffer_load_dwordx4 v[140:143], v14, s[8:11], s83 offen sc1
  s_mov_b32 s100, 1
L_plk_84:
  v_mov_b32 v6, 0
  v_msad_u8 v6, v144, v4, v6
  v_msad_u8 v6, v145, v4, v6
  v_msad_u8 v6, v146, v4, v6
  v_msad_u8 v6, v147, v4, v6
  v_cmp_ne_u32 vcc, 0, v6
  s_nop 0
  s_cbranch_vccz L_plk_85
  buffer_load_dwordx4 v[144:147], v14, s[8:11], s84 offen sc1
  s_mov_b32 s100, 1
L_plk_85:
  v_mov_b32 v6, 0
  v_msad_u8 v6, v148, v4, v6
  v_msad_u8 v6, v149, v4, v6
  v_msad_u8 v6, v150, v4, v6
  v_msad_u8 v6, v151, v4, v6
  v_cmp_ne_u32 vcc, 0, v6
  s_nop 0
  s_cbranch_vccz L_plk_86
  buffer_load_dwordx4 v[148:151], v14, s[8:11], s85 offen sc1
  s_mov_b32 s100, 1
L_plk_86:
  v_mov_b32 v6, 0
  v_msad_u8 v6, v152, v4, v6
  v_msad_u8 v6, v153, v4, v6
  v_msad_u8 v6, v154, v4, v6
  v_msad_u8 v6, v155, v4, v6
  v_cmp_ne_u32 vcc, 0, v6
  s_nop 0
  s_cbranch_vccz L_plk_87
  buffer_load_dwordx4 v[152:155], v14, s[8:11], s86 offen sc1
  s_mov_b32 s100, 1
L_plk_87:
  v_mov_b32 v6, 0
  v_msad_u8 v6, v156, v4, v6
  v_msad_u8 v6, v157, v4, v6
  v_msad_u8 v6, v158, v4, v6
  v_msad_u8 v6, v159, v4, v6
  v_cmp_ne_u32 vcc, 0, v6
  s_nop 0
  s_cbranch_vccz L_plk_88
  buffer_load_dwordx4 v[156:159], v14, s[8:11], s87 offen sc1
  s_mov_b32 s100, 1
L_plk_88:
  s_cmp_eq_u32 s100, 0
  s_cbranch_scc1 L_pld_79
  s_waitcnt vmcnt(0)
  s_add_u32 s15, s15, 1
  s_cmp_lt_u32 s15, 100000
  s_cbranch_scc1 L_pls_80
L_pld_79:
  v_add_f32 v128, v128, v132
  v_add_f32 v136, v136, v140
  v_add_f32 v144, v144, v148
  v_add_f32 v152, v152, v156
  v_add_f32 v128, v128, v136
  v_add_f32 v144, v144, v152
  v_add_f32 v128, v128, v144
  v_cvt_pk_bf16_f32 v128, v128, v128
  v_and_b32 v128, 0xffff0000, v128
  v_mul_f32 v128, v36, v128
  v_cvt_pk_bf16_f32 v128, v128, v128
  v_and_b32 v128, 0xffff0000, v128
  v_add_f32 v48, v32, v128
  v_cvt_pk_bf16_f32 v48, v48, v48
  v_and_b32 v48, 0xffff0000, v48
  v_add_f32 v129, v129, v133
  v_add_f32 v137, v137, v141
  v_add_f32 v145, v145, v149
  v_add_f32 v153, v153, v157
  v_add_f32 v129, v129, v137
  v_add_f32 v145, v145, v153
  v_add_f32 v129, v129, v145
  v_cvt_pk_bf16_f32 v129, v129, v129
  v_and_b32 v129, 0xffff0000, v129
  v_mul_f32 v129, v37, v129
  v_cvt_pk_bf16_f32 v129, v129, v129
  v_and_b32 v129, 0xffff0000, v129
  v_add_f32 v49, v33, v129
  v_cvt_pk_bf16_f32 v49, v49, v49
  v_and_b32 v49, 0xffff0000, v49
  v_add_f32 v130, v130, v134
  v_add_f32 v138, v138, v142
  v_add_f32 v146, v146, v150
  v_add_f32 v154, v154, v158
  v_add_f32 v130, v130, v138
  v_add_f32 v146, v146, v154
  v_add_f32 v130, v130, v146
  v_cvt_pk_bf16_f32 v130, v130, v130
  v_and_b32 v130, 0xffff0000, v130
  v_mul_f32 v130, v38, v130
  v_cvt_pk_bf16_f32 v130, v130, v130
  v_and_b32 v130, 0xffff0000, v130
  v_add_f32 v50, v34, v130
  v_cvt_pk_bf16_f32 v50, v50, v50
  v_and_b32 v50, 0xffff0000, v50
  v_add_f32 v131, v131, v135
  v_add_f32 v139, v139, v143
  v_add_f32 v147, v147, v151
  v_add_f32 v155, v155, v159
  v_add_f32 v131, v131, v139
  v_add_f32 v147, v147, v155
  v_add_f32 v131, v131, v147
  v_cvt_pk_bf16_f32 v131, v131, v131
  v_and_b32 v131, 0xffff0000, v131
  v_mul_f32 v131, v39, v131
  v_cvt_pk_bf16_f32 v131, v131, v131
  v_and_b32 v131, 0xffff0000, v131
  v_add_f32 v51, v35, v131
  v_cvt_pk_bf16_f32 v51, v51, v51
  v_and_b32 v51, 0xffff0000, v51
  v_add_f32 v128, v48, v49
  v_add_f32 v129, v50, v51
  v_add_f32 v128, v128, v129
  v_mul_f32 v129, v48, v48
  v_fmac_f32 v129, v49, v49
  v_fmac_f32 v129, v50, v50
  v_fmac_f32 v129, v51, v51
  v_cmp_eq_u32 vcc, 0, v17
  s_nop 1
  v_cndmask_b32 v130, 0, v128, vcc
  v_cndmask_b32 v131, 0, v129, vcc
  v_cndmask_b32 v132, v128, 0, vcc
  v_cndmask_b32 v133, v129, 0, vcc
  v_add_f32 v120, v120, v130
  v_add_f32 v121, v121, v131
  v_add_f32 v122, v122, v132
  v_add_f32 v123, v123, v133
  s_cmp_lg_u32 s23, 0
  s_cbranch_scc1 L_sk_89
  v_bfi_b32 v136, s14, v4, v48
  v_bfi_b32 v137, s14, v4, v49
  v_bfi_b32 v138, s14, v4, v50
  v_bfi_b32 v139, s14, v4, v51
  s_mov_b32 s48, 884736
  buffer_store_dwordx4 v[136:139], v14, s[8:11], s48 offen sc1
L_sk_89:
  s_branch L_jn_78
L_w0_77:
  buffer_load_dwordx4 v[128:131], v14, s[8:11], s80 offen sc1
  buffer_load_dwordx4 v[132:135], v14, s[8:11], s81 offen sc1
  buffer_load_dwordx4 v[136:139], v14, s[8:11], s82 offen sc1
  buffer_load_dwordx4 v[140:143], v14, s[8:11], s83 offen sc1
  buffer_load_dwordx4 v[144:147], v14, s[8:11], s84 offen sc1
  buffer_load_dwordx4 v[148:151], v14, s[8:11], s85 offen sc1
  buffer_load_dwordx4 v[152:155], v14, s[8:11], s86 offen sc1
  buffer_load_dwordx4 v[156:159], v14, s[8:11], s87 offen sc1
  buffer_load_dwordx4 v[160:163], v18, s[8:11], s80 offen sc1
  buffer_load_dwordx4 v[164:167], v18, s[8:11], s81 offen sc1
  buffer_load_dwordx4 v[168:171], v18, s[8:11], s82 offen sc1
  buffer_load_dwordx4 v[172:175], v18, s[8:11], s83 offen sc1
  buffer_load_dwordx4 v[176:179], v18, s[8:11], s84 offen sc1
  buffer_load_dwordx4 v[180:183], v18, s[8:11], s85 offen sc1
  buffer_load_dwordx4 v[184:187], v18, s[8:11], s86 offen sc1
  buffer_load_dwordx4 v[188:191], v18, s[8:11], s87 offen sc1
  v_mov_b32 v6, 0
  s_waitcnt vmcnt(15)
  v_msad_u8 v6, v128, v4, v6
  v_msad_u8 v6, v129, v4, v6
  v_msad_u8 v6, v130, v4, v6
  v_msad_u8 v6, v131, v4, v6
  s_waitcnt vmcnt(14)
  v_msad_u8 v6, v132, v4, v6
  v_msad_u8 v6, v133, v4, v6
  v_msad_u8 v6, v134, v4, v6
  v_msad_u8 v6, v135, v4, v6
  s_waitcnt vmcnt(13)
  v_msad_u8 v6, v136, v4, v6
  v_msad_u8 v6, v137, v4, v6
  v_msad_u8 v6, v138, v4, v6
  v_msad_u8 v6, v139, v4, v6
  s_waitcnt vmcnt(12)
  v_msad_u8 v6, v140, v4, v6
  v_msad_u8 v6, v141, v4, v6
  v_msad_u8 v6, v142, v4, v6
  v_msad_u8 v6, v143, v4, v6
  s_waitcnt vmcnt(11)
  v_msad_u8 v6, v144, v4, v6
  v_msad_u8 v6, v145, v4, v6
  v_msad_u8 v6, v146, v4, v6
  v_msad_u8 v6, v147, v4, v6
  s_waitcnt vmcnt(10)
  v_msad_u8 v6, v148, v4, v6
  v_msad_u8 v6, v149, v4, v6
  v_msad_u8 v6, v150, v4, v6
  v_msad_u8 v6, v151, v4, v6
  s_waitcnt vmcnt(9)
  v_msad_u8 v6, v152, v4, v6
  v_msad_u8 v6, v153, v4, v6
  v_msad_u8 v6, v154, v4, v6
  v_msad_u8 v6, v155, v4, v6
  s_waitcnt vmcnt(8)
  v_msad_u8 v6, v156, v4, v6
  v_msad_u8 v6, v157, v4, v6
  v_msad_u8 v6, v158, v4, v6
  v_msad_u8 v6, v159, v4, v6
  s_waitcnt vmcnt(7)
  v_msad_u8 v6, v160, v4, v6
  v_msad_u8 v6, v161, v4, v6
  v_msad_u8 v6, v162, v4, v6
  v_msad_u8 v6, v163, v4, v6
  s_waitcnt vmcnt(6)
  v_msad_u8 v6, v164, v4, v6
  v_msad_u8 v6, v165, v4, v6
  v_msad_u8 v6, v166, v4, v6
  v_msad_u8 v6, v167, v4, v6
  s_waitcnt vmcnt(5)
  v_msad_u8 v6, v168, v4, v6
  v_msad_u8 v6, v169, v4, v6
  v_msad_u8 v6, v170, v4, v6
  v_msad_u8 v6, v171, v4, v6
  s_waitcnt vmcnt(4)
  v_msad_u8 v6, v172, v4, v6
  v_msad_u8 v6, v173, v4, v6
  v_msad_u8 v6, v174, v4, v6
  v_msad_u8 v6, v175, v4, v6
  s_waitcnt vmcnt(3)
  v_msad_u8 v6, v176, v4, v6
  v_msad_u8 v6, v177, v4, v6
  v_msad_u8 v6, v178, v4, v6
  v_msad_u8 v6, v179, v4, v6
  s_waitcnt vmcnt(2)
  v_msad_u8 v6, v180, v4, v6
  v_msad_u8 v6, v181, v4, v6
  v_msad_u8 v6, v182, v4, v6
  v_msad_u8 v6, v183, v4, v6
  s_waitcnt vmcnt(1)
  v_msad_u8 v6, v184, v4, v6
  v_msad_u8 v6, v185, v4, v6
  v_msad_u8 v6, v186, v4, v6
  v_msad_u8 v6, v187, v4, v6
  s_waitcnt vmcnt(0)
  v_msad_u8 v6, v188, v4, v6
  v_msad_u8 v6, v189, v4, v6
  v_msad_u8 v6, v190, v4, v6
  v_msad_u8 v6, v191, v4, v6
  v_cmp_ne_u32 vcc, 0, v6
  s_nop 0
  s_cbranch_vccz L_pld_90
L_pls_91:
  s_mov_b32 s100, 0
  v_mov_b32 v6, 0
  v_msad_u8 v6, v128, v4, v6
  v_msad_u8 v6, v129, v4, v6
  v_msad_u8 v6, v130, v4, v6
  v_msad_u8 v6, v131, v4, v6
  v_cmp_ne_u32 vcc, 0, v6
  s_nop 0
  s_cbranch_vccz L_plk_92
  buffer_load_dwordx4 v[128:131], v14, s[8:11], s80 offen sc1
  s_mov_b32 s100, 1
L_plk_92:
  v_mov_b32 v6, 0
  v_msad_u8 v6, v132, v4, v6
  v_msad_u8 v6, v133, v4, v6
  v_msad_u8 v6, v134, v4, v6
  v_msad_u8 v6, v135, v4, v6
  v_cmp_ne_u32 vcc, 0, v6
  s_nop 0
  s_cbranch_vccz L_plk_93
  buffer_load_dwordx4 v[132:135], v14, s[8:11], s81 offen sc1
  s_mov_b32 s100, 1
L_plk_93:
  v_mov_b32 v6, 0
  v_msad_u8 v6, v136, v4, v6
  v_msad_u8 v6, v137, v4, v6
  v_msad_u8 v6, v138, v4, v6
  v_msad_u8 v6, v139, v4, v6
  v_cmp_ne_u32 vcc, 0, v6
  s_nop 0
  s_cbranch_vccz L_plk_94
  buffer_load_dwordx4 v[136:139], v14, s[8:11], s82 offen sc1
  s_mov_b32 s100, 1
L_plk_94:
  v_mov_b32 v6, 0
  v_msad_u8 v6, v140, v4, v6
  v_msad_u8 v6, v141, v4, v6
  v_msad_u8 v6, v142, v4, v6
  v_msad_u8 v6, v143, v4, v6
  v_cmp_ne_u32 vcc, 0, v6
  s_nop 0
  s_cbranch_vccz L_plk_95
  buffer_load_dwordx4 v[140:143], v14, s[8:11], s83 offen sc1
  s_mov_b32 s100, 1
L_plk_95:
  v_mov_b32 v6, 0
  v_msad_u8 v6, v144, v4, v6
  v_msad_u8 v6, v145, v4, v6
  v_msad_u8 v6, v146, v4, v6
  v_msad_u8 v6, v147, v4, v6
  v_cmp_ne_u32 vcc, 0, v6
  s_nop 0
  s_cbranch_vccz L_plk_96
  buffer_load_dwordx4 v[144:147], v14, s[8:11], s84 offen sc1
  s_mov_b32 s100, 1
L_plk_96:
  v_mov_b32 v6, 0
  v_msad_u8 v6, v148, v4, v6
  v_msad_u8 v6, v149, v4, v6
  v_msad_u8 v6, v150, v4, v6
  v_msad_u8 v6, v151, v4, v6
  v_cmp_ne_u32 vcc, 0, v6
  s_nop 0
  s_cbranch_vccz L_plk_97
  buffer_load_dwordx4 v[148:151], v14, s[8:11], s85 offen sc1
  s_mov_b32 s100, 1
L_plk_97:
  v_mov_b32 v6, 0
  v_msad_u8 v6, v152, v4, v6
  v_msad_u8 v6, v153, v4, v6
  v_msad_u8 v6, v154, v4, v6
  v_msad_u8 v6, v155, v4, v6
  v_cmp_ne_u32 vcc, 0, v6
  s_nop 0
  s_cbranch_vccz L_plk_98
  buffer_load_dwordx4 v[152:155], v14, s[8:11], s86 offen sc1
  s_mov_b32 s100, 1
L_plk_98:
  v_mov_b32 v6, 0
  v_msad_u8 v6, v156, v4, v6
  v_msad_u8 v6, v157, v4, v6
  v_msad_u8 v6, v158, v4, v6
  v_msad_u8 v6, v159, v4, v6
  v_cmp_ne_u32 vcc, 0, v6
  s_nop 0
  s_cbranch_vccz L_plk_99
  buffer_load_dwordx4 v[156:159], v14, s[8:11], s87 offen sc1
  s_mov_b32 s100, 1
L_plk_99:
  v_mov_b32 v6, 0
  v_msad_u8 v6, v160, v4, v6
  v_msad_u8 v6, v161, v4, v6
  v_msad_u8 v6, v162, v4, v6
  v_msad_u8 v6, v163, v4, v6
  v_cmp_ne_u32 vcc, 0, v6
  s_nop 0
  s_cbranch_vccz L_plk_100
  buffer_load_dwordx4 v[160:163], v18, s[8:11], s80 offen sc1
  s_mov_b32 s100, 1
L_plk_100:
  v_mov_b32 v6, 0
  v_msad_u8 v6, v164, v4, v6
  v_msad_u8 v6, v165, v4, v6
  v_msad_u8 v6, v166, v4, v6
  v_msad_u8 v6, v167, v4, v6
  v_cmp_ne_u32 vcc, 0, v6
  s_nop 0
  s_cbranch_vccz L_plk_101
  buffer_load_dwordx4 v[164:167], v18, s[8:11], s81 offen sc1
  s_mov_b32 s100, 1
L_plk_101:
  v_mov_b32 v6, 0
  v_msad_u8 v6, v168, v4, v6
  v_msad_u8 v6, v169, v4, v6
  v_msad_u8 v6, v170, v4, v6
  v_msad_u8 v6, v171, v4, v6
  v_cmp_ne_u32 vcc, 0, v6
  s_nop 0
  s_cbranch_vccz L_plk_102
  buffer_load_dwordx4 v[168:171], v18, s[8:11], s82 offen sc1
  s_mov_b32 s100, 1
L_plk_102:
  v_mov_b32 v6, 0
  v_msad_u8 v6, v172, v4, v6
  v_msad_u8 v6, v173, v4, v6
  v_msad_u8 v6, v174, v4, v6
  v_msad_u8 v6, v175, v4, v6
  v_cmp_ne_u32 vcc, 0, v6
  s_nop 0
  s_cbranch_vccz L_plk_103
  buffer_load_dwordx4 v[172:175], v18, s[8:11], s83 offen sc1
  s_mov_b32 s100, 1
L_plk_103:
  v_mov_b32 v6, 0
  v_msad_u8 v6, v176, v4, v6
  v_msad_u8 v6, v177, v4, v6
  v_msad_u8 v6, v178, v4, v6
  v_msad_u8 v6, v179, v4, v6
  v_cmp_ne_u32 vcc, 0, v6
  s_nop 0
  s_cbranch_vccz L_plk_104
  buffer_load_dwordx4 v[176:179], v18, s[8:11], s84 offen sc1
  s_mov_b32 s100, 1
L_plk_104:
  v_mov_b32 v6, 0
  v_msad_u8 v6, v180, v4, v6
  v_msad_u8 v6, v181, v4, v6
  v_msad_u8 v6, v182, v4, v6
  v_msad_u8 v6, v183, v4, v6
  v_cmp_ne_u32 vcc, 0, v6
  s_nop 0
  s_cbranch_vccz L_plk_105
  buffer_load_dwordx4 v[180:183], v18, s[8:11], s85 offen sc1
  s_mov_b32 s100, 1
L_plk_105:
  v_mov_b32 v6, 0
  v_msad_u8 v6, v184, v4, v6
  v_msad_u8 v6, v185, v4, v6
  v_msad_u8 v6, v186, v4, v6
  v_msad_u8 v6, v187, v4, v6
  v_cmp_ne_u32 vcc, 0, v6
  s_nop 0
  s_cbranch_vccz L_plk_106
  buffer_load_dwordx4 v[184:187], v18, s[8:11], s86 offen sc1
  s_mov_b32 s100, 1
L_plk_106:
  v_mov_b32 v6, 0
  v_msad_u8 v6, v188, v4, v6
  v_msad_u8 v6, v189, v4, v6
  v_msad_u8 v6, v190, v4, v6
  v_msad_u8 v6, v191, v4, v6
  v_cmp_ne_u32 vcc, 0, v6
  s_nop 0
  s_cbranch_vccz L_plk_107
  buffer_load_dwordx4 v[188:191], v18, s[8:11], s87 offen sc1
  s_mov_b32 s100, 1
L_plk_107:
  s_cmp_eq_u32 s100, 0
  s_cbranch_scc1 L_pld_90
  s_waitcnt vmcnt(0)
  s_add_u32 s15, s15, 1
  s_cmp_lt_u32 s15, 100000
  s_cbranch_scc1 L_pls_91
L_pld_90:
  v_add_f32 v128, v128, v132
  v_add_f32 v136, v136, v140
  v_add_f32 v144, v144, v148
  v_add_f32 v152, v152, v156
  v_add_f32 v128, v128, v136
  v_add_f32 v144, v144, v152
  v_add_f32 v128, v128, v144
  v_cvt_pk_bf16_f32 v128, v128, v128
  v_and_b32 v128, 0xffff0000, v128
  v_mul_f32 v128, v36, v128
  v_cvt_pk_bf16_f32 v128, v128, v128
  v_and_b32 v128, 0xffff0000, v128
  v_add_f32 v48, v32, v128
  v_cvt_pk_bf16_f32 v48, v48, v48
  v_and_b32 v48, 0xffff0000, v48
  v_add_f32 v129, v129, v133
  v_add_f32 v137, v137, v141
  v_add_f32 v145, v145, v149
  v_add_f32 v153, v153, v157
  v_add_f32 v129, v129, v137
  v_add_f32 v145, v145, v153
  v_add_f32 v129, v129, v145
  v_cvt_pk_bf16_f32 v129, v129, v129
  v_and_b32 v129, 0xffff0000, v129
  v_mul_f32 v129, v37, v129
  v_cvt_pk_bf16_f32 v129, v129, v129
  v_and_b32 v129, 0xffff0000, v129
  v_add_f32 v49, v33, v129
  v_cvt_pk_bf16_f32 v49, v49, v49
  v_and_b32 v49, 0xffff0000, v49
  v_add_f32 v130, v130, v134
  v_add_f32 v138, v138, v142
  v_add_f32 v146, v146, v150
  v_add_f32 v154, v154, v158
  v_add_f32 v130, v130, v138
  v_add_f32 v146, v146, v154
  v_add_f32 v130, v130, v146
  v_cvt_pk_bf16_f32 v130, v130, v130
  v_and_b32 v130, 0xffff0000, v130
  v_mul_f32 v130, v38, v130
  v_cvt_pk_bf16_f32 v130, v130, v130
  v_and_b32 v130, 0xffff0000, v130
  v_add_f32 v50, v34, v130
  v_cvt_pk_bf16_f32 v50, v50, v50
  v_and_b32 v50, 0xffff0000, v50
  v_add_f32 v131, v131, v135
  v_add_f32 v139, v139, v143
  v_add_f32 v147, v147, v151
  v_add_f32 v155, v155, v159
  v_add_f32 v131, v131, v139
  v_add_f32 v147, v147, v155
  v_add_f32 v131, v131, v147
  v_cvt_pk_bf16_f32 v131, v131, v131
  v_and_b32 v131, 0xffff0000, v131
  v_mul_f32 v131, v39, v131
  v_cvt_pk_bf16_f32 v131, v131, v131
  v_and_b32 v131, 0xffff0000, v131
  v_add_f32 v51, v35, v131
  v_cvt_pk_bf16_f32 v51, v51, v51
  v_and_b32 v51, 0xffff0000, v51
  v_add_f32 v128, v48, v49
  v_add_f32 v129, v50, v51
  v_add_f32 v128, v128, v129
  v_mul_f32 v129, v48, v48
  v_fmac_f32 v129, v49, v49
  v_fmac_f32 v129, v50, v50
  v_fmac_f32 v129, v51, v51
  v_cmp_eq_u32 vcc, 0, v17
  s_nop 1
  v_cndmask_b32 v130, 0, v128, vcc
  v_cndmask_b32 v131, 0, v129, vcc
  v_cndmask_b32 v132, v128, 0, vcc
  v_cndmask_b32 v133, v129, 0, vcc
  v_add_f32 v120, v120, v130
  v_add_f32 v121, v121, v131
  v_add_f32 v122, v122, v132
  v_add_f32 v123, v123, v133
  s_cmp_lg_u32 s23, 0
  s_cbranch_scc1 L_sk_108
  v_bfi_b32 v136, s14, v4, v48
  v_bfi_b32 v137, s14, v4, v49
  v_bfi_b32 v138, s14, v4, v50
  v_bfi_b32 v139, s14, v4, v51
  s_mov_b32 s48, 884736
  buffer_store_dwordx4 v[136:139], v14, s[8:11], s48 offen sc1
L_sk_108:
  v_add_f32 v160, v160, v164
  v_add_f32 v168, v168, v172
  v_add_f32 v176, v176, v180
  v_add_f32 v184, v184, v188
  v_add_f32 v160, v160, v168
  v_add_f32 v176, v176, v184
  v_add_f32 v160, v160, v176
  v_cvt_pk_bf16_f32 v160, v160, v160
  v_and_b32 v160, 0xffff0000, v160
  v_mul_f32 v160, v68, v160
  v_cvt_pk_bf16_f32 v160, v160, v160
  v_and_b32 v160, 0xffff0000, v160
  v_add_f32 v80, v64, v160
  v_cvt_pk_bf16_f32 v80, v80, v80
  v_and_b32 v80, 0xffff0000, v80
  v_add_f32 v161, v161, v165
  v_add_f32 v169, v169, v173
  v_add_f32 v177, v177, v181
  v_add_f32 v185, v185, v189
  v_add_f32 v161, v161, v169
  v_add_f32 v177, v177, v185
  v_add_f32 v161, v161, v177
  v_cvt_pk_bf16_f32 v161, v161, v161
  v_and_b32 v161, 0xffff0000, v161
  v_mul_f32 v161, v69, v161
  v_cvt_pk_bf16_f32 v161, v161, v161
  v_and_b32 v161, 0xffff0000, v161
  v_add_f32 v81, v65, v161
  v_cvt_pk_bf16_f32 v81, v81, v81
  v_and_b32 v81, 0xffff0000, v81
  v_add_f32 v162, v162, v166
  v_add_f32 v170, v170, v174
  v_add_f32 v178, v178, v182
  v_add_f32 v186, v186, v190
  v_add_f32 v162, v162, v170
  v_add_f32 v178, v178, v186
  v_add_f32 v162, v162, v178
  v_cvt_pk_bf16_f32 v162, v162, v162
  v_and_b32 v162, 0xffff0000, v162
  v_mul_f32 v162, v70, v162
  v_cvt_pk_bf16_f32 v162, v162, v162
  v_and_b32 v162, 0xffff0000, v162
  v_add_f32 v82, v66, v162
  v_cvt_pk_bf16_f32 v82, v82, v82
  v_and_b32 v82, 0xffff0000, v82
  v_add_f32 v163, v163, v167
  v_add_f32 v171, v171, v175
  v_add_f32 v179, v179, v183
  v_add_f32 v187, v187, v191
  v_add_f32 v163, v163, v171
  v_add_f32 v179, v179, v187
  v_add_f32 v163, v163, v179
  v_cvt_pk_bf16_f32 v163, v163, v163
  v_and_b32 v163, 0xffff0000, v163
  v_mul_f32 v163, v71, v163
  v_cvt_pk_bf16_f32 v163, v163, v163
  v_and_b32 v163, 0xffff0000, v163
  v_add_f32 v83, v67, v163
  v_cvt_pk_bf16_f32 v83, v83, v83
  v_and_b32 v83, 0xffff0000, v83
  v_add_f32 v160, v80, v81
  v_add_f32 v161, v82, v83
  v_add_f32 v160, v160, v161
  v_mul_f32 v161, v80, v80
  v_fmac_f32 v161, v81, v81
  v_fmac_f32 v161, v82, v82
  v_fmac_f32 v161, v83, v83
  v_cmp_eq_u32 vcc, 0, v21
  s_nop 1
  v_cndmask_b32 v162, 0, v160, vcc
  v_cndmask_b32 v163, 0, v161, vcc
  v_cndmask_b32 v164, v160, 0, vcc
  v_cndmask_b32 v165, v161, 0, vcc
  v_add_f32 v120, v120, v162
  v_add_f32 v121, v121, v163
  v_add_f32 v122, v122, v164
  v_add_f32 v123, v123, v165
  s_cmp_lg_u32 s23, 0
  s_cbranch_scc1 L_sk_109
  v_bfi_b32 v168, s14, v4, v80
  v_bfi_b32 v169, s14, v4, v81
  v_bfi_b32 v170, s14, v4, v82
  v_bfi_b32 v171, s14, v4, v83
  s_mov_b32 s48, 884736
  buffer_store_dwordx4 v[168:171], v18, s[8:11], s48 offen sc1
L_sk_109:
L_jn_78:
  v_add_f32_dpp v120, v120, v120 quad_perm:[1,0,3,2] row_mask:0xf bank_mask:0xf
  v_add_f32_dpp v121, v121, v121 quad_perm:[1,0,3,2] row_mask:0xf bank_mask:0xf
  v_add_f32_dpp v122, v122, v122 quad_perm:[1,0,3,2] row_mask:0xf bank_mask:0xf
  v_add_f32_dpp v123, v123, v123 quad_perm:[1,0,3,2] row_mask:0xf bank_mask:0xf
  v_add_f32_dpp v120, v120, v120 quad_perm:[2,3,0,1] row_mask:0xf bank_mask:0xf
  v_add_f32_dpp v121, v121, v121 quad_perm:[2,3,0,1] row_mask:0xf bank_mask:0xf
  v_add_f32_dpp v122, v122, v122 quad_perm:[2,3,0,1] row_mask:0xf bank_mask:0xf
  v_add_f32_dpp v123, v123, v123 quad_perm:[2,3,0,1] row_mask:0xf bank_mask:0xf
  v_add_f32_dpp v120, v120, v120 row_half_mirror row_mask:0xf bank_mask:0xf
  v_add_f32_dpp v121, v121, v121 row_half_mirror row_mask:0xf bank_mask:0xf
  v_add_f32_dpp v122, v122, v122 row_half_mirror row_mask:0xf bank_mask:0xf
  v_add_f32_dpp v123, v123, v123 row_half_mirror row_mask:0xf bank_mask:0xf
  v_add_f32_dpp v120, v120, v120 row_mirror row_mask:0xf bank_mask:0xf
  v_add_f32_dpp v121, v121, v121 row_mirror row_mask:0xf bank_mask:0xf
  v_add_f32_dpp v122, v122, v122 row_mirror row_mask:0xf bank_mask:0xf
  v_add_f32_dpp v123, v123, v123 row_mirror row_mask:0xf bank_mask:0xf
  v_mov_b32 v124, v120
  v_mov_b32 v125, v121
  v_mov_b32 v126, v122
  v_mov_b32 v127, v123
  v_permlane16_swap_b32 v120, v124
  v_permlane16_swap_b32 v121, v125
  v_permlane16_swap_b32 v122, v126
  v_permlane16_swap_b32 v123, v127
  v_add_f32 v120, v120, v124
  v_add_f32 v121, v121, v125
  v_add_f32 v122, v122, v126
  v_add_f32 v123, v123, v127
  v_mov_b32 v124, v120
  v_mov_b32 v125, v121
  v_mov_b32 v126, v122
  v_mov_b32 v127, v123
  v_permlane32_swap_b32 v120, v124
  v_permlane32_swap_b32 v121, v125
  v_permlane32_swap_b32 v122, v126
  v_permlane32_swap_b32 v123, v127
  v_add_f32 v120, v120, v124
  v_add_f32 v121, v121, v125
  v_add_f32 v122, v122, v126
  v_add_f32 v123, v123, v127
  s_lshl_b32 s48, s3, 4
  s_add_u32 s48, s48, 131072
  v_mov_b32 v6, s48
  s_mov_b64 s[44:45], exec
  s_mov_b64 exec, 1
  ds_write_b128 v6, v[120:123]
  s_mov_b64 exec, s[44:45]
  s_waitcnt lgkmcnt(0)
  s_barrier
  v_mov_b32 v6, 131072
  ds_read_b128 v[128:131], v6 offset:0
  ds_read_b128 v[132:135], v6 offset:16
  ds_read_b128 v[136:139], v6 offset:32
  ds_read_b128 v[140:143], v6 offset:48
  s_waitcnt lgkmcnt(0)
  v_add_f32 v128, v128, v132
  v_add_f32 v136, v136, v140
  v_add_f32 v128, v128, v136
  v_add_f32 v129, v129, v133
  v_add_f32 v137, v137, v141
  v_add_f32 v129, v129, v137
  v_add_f32 v130, v130, v134
  v_add_f32 v138, v138, v142
  v_add_f32 v130, v130, v138
  v_add_f32 v131, v131, v135
  v_add_f32 v139, v139, v143
  v_add_f32 v131, v131, v139
  v_mul_f32 v128, 0x3acccccd, v128
  v_mul_f32 v129, 0x3acccccd, v129
  v_fma_f32 v129, -v128, v128, v129
  v_max_f32 v129, 0, v129
  v_cvt_pk_bf16_f32 v129, v129, v129
  v_and_b32 v129, 0xffff0000, v129
  v_add_f32 v129, 0x3727c5ac, v129
  v_cvt_pk_bf16_f32 v129, v129, v129
  v_and_b32 v129, 0xffff0000, v129
  v_sqrt_f32 v129, v129
  s_nop 0
  v_cvt_pk_bf16_f32 v129, v129, v129
  v_and_b32 v129, 0xffff0000, v129
  v_rcp_f32 v129, v129
  v_cvt_pk_bf16_f32 v128, v128, v128
  v_and_b32 v128, 0xffff0000, v128
  v_mul_f32 v130, 0x3acccccd, v130
  v_mul_f32 v131, 0x3acccccd, v131
  v_fma_f32 v131, -v130, v130, v131
  v_max_f32 v131, 0, v131
  v_cvt_pk_bf16_f32 v131, v131, v131
  v_and_b32 v131, 0xffff0000, v131
  v_add_f32 v131, 0x3727c5ac, v131
  v_cvt_pk_bf16_f32 v131, v131, v131
  v_and_b32 v131, 0xffff0000, v131
  v_sqrt_f32 v131, v131
  s_nop 0
  v_cvt_pk_bf16_f32 v131, v131, v131
  v_and_b32 v131, 0xffff0000, v131
  v_rcp_f32 v131, v131
  v_cvt_pk_bf16_f32 v130, v130, v130
  v_and_b32 v130, 0xffff0000, v130
  v_cmp_eq_u32 vcc, 0, v17
  s_nop 1
  v_cndmask_b32 v132, v130, v128, vcc
  v_cndmask_b32 v133, v131, v129, vcc
  v_sub_f32 v134, v48, v132
  v_cvt_pk_bf16_f32 v134, v134, v134
  v_and_b32 v134, 0xffff0000, v134
  v_mul_f32 v134, v134, v133
  v_cvt_pk_bf16_f32 v134, v134, v134
  v_and_b32 v134, 0xffff0000, v134
  v_mul_f32 v134, v134, v44
  v_cvt_pk_bf16_f32 v134, v134, v134
  v_and_b32 v134, 0xffff0000, v134
  v_add_f32 v134, v134, v40
  v_sub_f32 v135, v49, v132
  v_cvt_pk_bf16_f32 v135, v135, v135
  v_and_b32 v135, 0xffff0000, v135
  v_mul_f32 v135, v135, v133
  v_cvt_pk_bf16_f32 v135, v135, v135
  v_and_b32 v135, 0xffff0000, v135
  v_mul_f32 v135, v135, v45
  v_cvt_pk_bf16_f32 v135, v135, v135
  v_and_b32 v135, 0xffff0000, v135
  v_add_f32 v135, v135, v41
  v_sub_f32 v136, v50, v132
  v_cvt_pk_bf16_f32 v136, v136, v136
  v_and_b32 v136, 0xffff0000, v136
  v_mul_f32 v136, v136, v133
  v_cvt_pk_bf16_f32 v136, v136, v136
  v_and_b32 v136, 0xffff0000, v136
  v_mul_f32 v136, v136, v46
  v_cvt_pk_bf16_f32 v136, v136, v136
  v_and_b32 v136, 0xffff0000, v136
  v_add_f32 v136, v136, v42
  v_sub_f32 v137, v51, v132
  v_cvt_pk_bf16_f32 v137, v137, v137
  v_and_b32 v137, 0xffff0000, v137
  v_mul_f32 v137, v137, v133
  v_cvt_pk_bf16_f32 v137, v137, v137
  v_and_b32 v137, 0xffff0000, v137
  v_mul_f32 v137, v137, v47
  v_cvt_pk_bf16_f32 v137, v137, v137
  v_and_b32 v137, 0xffff0000, v137
  v_add_f32 v137, v137, v43
  v_cvt_pk_bf16_f32 v134, v134, v135
  v_cvt_pk_bf16_f32 v135, v136, v137
  ds_write_b64 v16, v[134:135]
  s_cmp_lg_u32 s3, 0
  s_cbranch_scc1 L_sk_110
  v_cmp_eq_u32 vcc, 0, v21
  s_nop 1
  v_cndmask_b32 v132, v130, v128, vcc
  v_cndmask_b32 v133, v131, v129, vcc
  v_sub_f32 v134, v80, v132
  v_cvt_pk_bf16_f32 v134, v134, v134
  v_and_b32 v134, 0xffff0000, v134
  v_mul_f32 v134, v134, v133
  v_cvt_pk_bf16_f32 v134, v134, v134
  v_and_b32 v134, 0xffff0000, v134
  v_mul_f32 v134, v134, v76
  v_cvt_pk_bf16_f32 v134, v134, v134
  v_and_b32 v134, 0xffff0000, v134
  v_add_f32 v134, v134, v72
  v_sub_f32 v135, v81, v132
  v_cvt_pk_bf16_f32 v135, v135, v135
  v_and_b32 v135, 0xffff0000, v135
  v_mul_f32 v135, v135, v133
  v_cvt_pk_bf16_f32 v135, v135, v135
  v_and_b32 v135, 0xffff0000, v135
  v_mul_f32 v135, v135, v77
  v_cvt_pk_bf16_f32 v135, v135, v135
  v_and_b32 v135, 0xffff0000, v135
  v_add_f32 v135, v135, v73
  v_sub_f32 v136, v82, v132
  v_cvt_pk_bf16_f32 v136, v136, v136
  v_and_b32 v136, 0xffff0000, v136
  v_mul_f32 v136, v136, v133
  v_cvt_pk_bf16_f32 v136, v136, v136
  v_and_b32 v136, 0xffff0000, v136
  v_mul_f32 v136, v136, v78
  v_cvt_pk_bf16_f32 v136, v136, v136
  v_and_b32 v136, 0xffff0000, v136
  v_add_f32 v136, v136, v74
  v_sub_f32 v137, v83, v132
  v_cvt_pk_bf16_f32 v137, v137, v137
  v_and_b32 v137, 0xffff0000, v137
  v_mul_f32 v137, v137, v133
  v_cvt_pk_bf16_f32 v137, v137, v137
  v_and_b32 v137, 0xffff0000, v137
  v_mul_f32 v137, v137, v79
  v_cvt_pk_bf16_f32 v137, v137, v137
  v_and_b32 v137, 0xffff0000, v137
  v_add_f32 v137, v137, v75
  v_cvt_pk_bf16_f32 v134, v134, v135
  v_cvt_pk_bf16_f32 v135, v136, v137
  ds_write_b64 v20, v[134:135]
L_sk_110:
  s_waitcnt lgkmcnt(0)
  s_barrier
  ds_read_b128 v[128:131], v22 offset:0
  ds_read_b128 v[132:135], v22 offset:64
  ds_read_b128 v[136:139], v22 offset:128
  ds_read_b128 v[140:143], v22 offset:192
  ds_read_b128 v[144:147], v22 offset:256
  v_mov_b32 v160, 0
  v_mov_b32 v161, 0
  v_mov_b32 v162, 0
  v_mov_b32 v163, 0
  v_mov_b32 v164, 0
  v_mov_b32 v165, 0
  v_mov_b32 v166, 0
  v_mov_b32 v167, 0
  v_mov_b32 v168, 0
  v_mov_b32 v169, 0
  v_mov_b32 v170, 0
  v_mov_b32 v171, 0
  v_mov_b32 v172, 0
  v_mov_b32 v173, 0
  v_mov_b32 v174, 0
  v_mov_b32 v175, 0
  v_mov_b32 v176, 0
  v_mov_b32 v177, 0
  v_mov_b32 v178, 0
  v_mov_b32 v179, 0
  v_mov_b32 v180, 0
  v_mov_b32 v181, 0
  v_mov_b32 v182, 0
  v_mov_b32 v183, 0
  v_mov_b32 v184, 0
  v_mov_b32 v185, 0
  v_mov_b32 v186, 0
  v_mov_b32 v187, 0
  v_mov_b32 v188, 0
  v_mov_b32 v189, 0
  v_mov_b32 v190, 0
  v_mov_b32 v191, 0
  s_lshr_b32 s56, s3, 1
  s_lshl_b32 s48, s56, 9
  s_and_b32 s49, s3, 1
  s_lshl_b32 s49, s49, 7
  s_add_u32 s48, s48, s49
  s_add_u32 s48, s48, 126976
  v_lshlrev_b32 v26, 2, v1
  v_add_u32 v27, s48, v26
  s_mul_i32 s60, s56, 6912
  s_lshl_b32 s61, s23, 8
  s_add_u32 s60, s60, s61
  s_add_u32 s60, s60, s49
  s_add_u32 s60, s60, 851968
  s_waitcnt lgkmcnt(4)
  v_mfma_f32_16x16x32_bf16 v[160:163], a[0:3], v[128:131], v[160:163]
  v_mfma_f32_16x16x32_bf16 v[164:167], a[4:7], v[128:131], v[164:167]
  v_mfma_f32_16x16x32_bf16 v[168:171], a[8:11], v[128:131], v[168:171]
  v_mfma_f32_16x16x32_bf16 v[172:175], a[12:15], v[128:131], v[172:175]
  v_mfma_f32_16x16x32_bf16 v[176:179], a[16:19], v[128:131], v[176:179]
  v_mfma_f32_16x16x32_bf16 v[180:183], a[20:23], v[128:131], v[180:183]
  v_mfma_f32_16x16x32_bf16 v[184:187], a[24:27], v[128:131], v[184:187]
  v_mfma_f32_16x16x32_bf16 v[188:191], a[28:31], v[128:131], v[188:191]
  s_waitcnt lgkmcnt(3)
  v_mfma_f32_16x16x32_bf16 v[160:163], a[32:35], v[132:135], v[160:163]
  v_mfma_f32_16x16x32_bf16 v[164:167], a[36:39], v[132:135], v[164:167]
  v_mfma_f32_16x16x32_bf16 v[168:171], a[40:43], v[132:135], v[168:171]
  v_mfma_f32_16x16x32_bf16 v[172:175], a[44:47], v[132:135], v[172:175]
  v_mfma_f32_16x16x32_bf16 v[176:179], a[48:51], v[132:135], v[176:179]
  v_mfma_f32_16x16x32_bf16 v[180:183], a[52:55], v[132:135], v[180:183]
  v_mfma_f32_16x16x32_bf16 v[184:187], a[56:59], v[132:135], v[184:187]
  v_mfma_f32_16x16x32_bf16 v[188:191], a[60:63], v[132:135], v[188:191]
  s_waitcnt lgkmcnt(2)
  v_mfma_f32_16x16x32_bf16 v[160:163], a[64:67], v[136:139], v[160:163]
  v_mfma_f32_16x16x32_bf16 v[164:167], a[68:71], v[136:139], v[164:167]
  v_mfma_f32_16x16x32_bf16 v[168:171], a[72:75], v[136:139], v[168:171]
  v_mfma_f32_16x16x32_bf16 v[172:175], a[76:79], v[136:139], v[172:175]
  v_mfma_f32_16x16x32_bf16 v[176:179], a[80:83], v[136:139], v[176:179]
  v_mfma_f32_16x16x32_bf16 v[180:183], a[84:87], v[136:139], v[180:183]
  v_mfma_f32_16x16x32_bf16 v[184:187], a[88:91], v[136:139], v[184:187]
  v_mfma_f32_16x16x32_bf16 v[188:191], a[92:95], v[136:139], v[188:191]
  s_waitcnt lgkmcnt(1)
  v_mfma_f32_16x16x32_bf16 v[160:163], a[96:99], v[140:143], v[160:163]
  v_mfma_f32_16x16x32_bf16 v[164:167], a[100:103], v[140:143], v[164:167]
  v_mfma_f32_16x16x32_bf16 v[168:171], a[104:107], v[140:143], v[168:171]
  v_mfma_f32_16x16x32_bf16 v[172:175], a[108:111], v[140:143], v[172:175]
  v_mfma_f32_16x16x32_bf16 v[176:179], a[112:115], v[140:143], v[176:179]
  v_mfma_f32_16x16x32_bf16 v[180:183], a[116:119], v[140:143], v[180:183]
  v_mfma_f32_16x16x32_bf16 v[184:187], a[120:123], v[140:143], v[184:187]
  v_mfma_f32_16x16x32_bf16 v[188:191], a[124:127], v[140:143], v[188:191]
  s_waitcnt lgkmcnt(0)
  v_mfma_f32_16x16x32_bf16 v[160:163], a[128:131], v[144:147], v[160:163]
  v_mfma_f32_16x16x32_bf16 v[164:167], a[132:135], v[144:147], v[164:167]
  v_mfma_f32_16x16x32_bf16 v[168:171], a[136:139], v[144:147], v[168:171]
  v_mfma_f32_16x16x32_bf16 v[172:175], a[140:143], v[144:147], v[172:175]
  v_mfma_f32_16x16x32_bf16 v[176:179], a[144:147], v[144:147], v[176:179]
  v_mfma_f32_16x16x32_bf16 v[180:183], a[148:151], v[144:147], v[180:183]
  v_mfma_f32_16x16x32_bf16 v[184:187], a[152:155], v[144:147], v[184:187]
  v_mfma_f32_16x16x32_bf16 v[188:191], a[156:159], v[144:147], v[188:191]
  s_cmp_ge_u32 s23, 8
  s_cbranch_scc1 L_nr_111
  s_cmp_lg_u32 s3, 0
  s_cbranch_scc1 L_nr_111
  v_mov_b32 v6, s13
  s_lshl_b32 s48, s17, 7
  s_add_u32 s48, s48, 11264
  s_mov_b64 s[44:45], exec
  s_mov_b64 exec, 1
  buffer_store_dword v6, v5, s[8:11], s48 offen sc1
  s_mov_b64 exec, s[44:45]
L_nr_111:
  s_mov_b64 s[44:45], exec
  s_mov_b64 exec, s[46:47]
  ds_write_b128 v23, v[160:163] offset:0
  ds_write_b128 v23, v[164:167] offset:64
  ds_write_b128 v23, v[168:171] offset:128
  ds_write_b128 v23, v[172:175] offset:192
  ds_write_b128 v23, v[176:179] offset:256
  ds_write_b128 v23, v[180:183] offset:320
  ds_write_b128 v23, v[184:187] offset:384
  ds_write_b128 v23, v[188:191] offset:448
  s_mov_b64 exec, s[44:45]
  s_waitcnt lgkmcnt(0)
  s_barrier
  v_cmp_gt_u32 vcc, 32, v1
  s_nop 0
  s_and_saveexec_b64 s[44:45], vcc
  ds_read_b32 v128, v27 offset:0
  ds_read_b32 v129, v27 offset:256
  ds_read_b32 v130, v27 offset:1024
  ds_read_b32 v131, v27 offset:1280
  ds_read_b32 v132, v27 offset:2048
  ds_read_b32 v133, v27 offset:2304
  ds_read_b32 v134, v27 offset:3072
  ds_read_b32 v135, v27 offset:3328
  s_waitcnt lgkmcnt(0)
  v_add_f32 v128, v128, v130
  v_add_f32 v132, v132, v134
  v_add_f32 v128, v128, v132
  v_cvt_pk_bf16_f32 v128, v128, v128
  v_and_b32 v128, 0xffff0000, v128
  v_add_f32 v129, v129, v131
  v_add_f32 v133, v133, v135
  v_add_f32 v129, v129, v133
  v_cvt_pk_bf16_f32 v129, v129, v129
  v_and_b32 v129, 0xffff0000, v129
  v_mul_f32 v128, 0xbfb8aa3b, v128
  v_exp_f32 v128, v128
  s_nop 0
  v_add_f32 v128, 1.0, v128
  v_rcp_f32 v128, v128
  s_nop 0
  v_cvt_pk_bf16_f32 v128, v128, v128
  v_and_b32 v128, 0xffff0000, v128
  v_mul_f32 v128, v128, v129
  v_cvt_pk_bf16_f32 v128, v128, v128
  v_and_b32 v128, 0xffff0000, v128
  v_bfi_b32 v128, s14, v4, v128
  buffer_store_dword v128, v26, s[8:11], s60 offen sc1
  s_mov_b64 exec, s[44:45]
  s_endpgm
L_H:
  buffer_load_dwordx4 a[40:43], v12, s[52:55], s76 offen nt
  s_add_u32 s76, s76, 20480
  buffer_load_dwordx4 a[44:47], v12, s[52:55], s76 offen nt
  s_add_u32 s76, s76, 20480
  buffer_load_dwordx4 a[48:51], v12, s[52:55], s76 offen nt
  s_add_u32 s76, s76, 20480
  buffer_load_dwordx4 a[52:55], v12, s[52:55], s76 offen nt
  s_add_u32 s76, s76, 20480
  buffer_load_dwordx4 a[56:59], v12, s[52:55], s76 offen nt
  s_add_u32 s76, s76, 20480
  buffer_load_dwordx4 a[60:63], v12, s[52:55], s76 offen nt
  s_add_u32 s76, s76, 20480
  buffer_load_dwordx4 a[64:67], v12, s[52:55], s76 offen nt
  s_add_u32 s76, s76, 20480
  buffer_load_dwordx4 a[68:71], v12, s[52:55], s76 offen nt
  s_add_u32 s76, s76, 20480
  buffer_load_dwordx4 a[72:75], v12, s[52:55], s76 offen nt
  s_add_u32 s76, s76, 20480
  buffer_load_dwordx4 a[76:79], v12, s[52:55], s76 offen nt
  s_add_u32 s76, s76, 20480
  buffer_load_dwordx4 a[80:83], v12, s[52:55], s76 offen nt
  s_add_u32 s76, s76, 20480
  buffer_load_dwordx4 a[84:87], v12, s[52:55], s76 offen nt
  s_add_u32 s76, s76, 20480
  buffer_load_dwordx4 a[88:91], v12, s[52:55], s76 offen nt
  s_add_u32 s76, s76, 20480
  buffer_load_dwordx4 a[92:95], v12, s[52:55], s76 offen nt
  s_add_u32 s76, s76, 20480
  buffer_load_dwordx4 a[96:99], v12, s[52:55], s76 offen nt
  s_add_u32 s76, s76, 20480
  buffer_load_dwordx4 a[100:103], v12, s[52:55], s76 offen nt
  s_add_u32 s76, s76, 20480
  buffer_load_dwordx4 a[104:107], v12, s[52:55], s76 offen nt
  s_add_u32 s76, s76, 20480
  buffer_load_dwordx4 a[108:111], v12, s[52:55], s76 offen nt
  s_add_u32 s76, s76, 20480
  v_add_u32 v6, 0, v0
  v_lshlrev_b32 v14, 4, v6
  v_cmp_le_u32 vcc, 432, v6
  s_nop 1
  v_cndmask_b32 v7, 0, 1, vcc
  v_mul_u32_u24 v8, 432, v7
  v_sub_u32 v6, v6, v8
  v_mul_u32_u24 v8, 607, v6
  v_lshrrev_b32 v8, 16, v8
  v_mul_u32_u24 v9, 108, v8
  v_sub_u32 v6, v6, v9
  v_lshl_add_u32 v8, v8, 1, v7
  v_mul_u32_u24 v8, 14, v8
  v_lshrrev_b32 v9, 3, v6
  v_add_u32 v8, v8, v9
  v_lshlrev_b32 v8, 6, v8
  v_and_b32 v9, 3, v6
  v_lshl_add_u32 v8, v9, 4, v8
  v_bfe_u32 v9, v6, 2, 1
  v_lshl_add_u32 v8, v9, 3, v8
  v_add_u32 v18, 118784, v8
  v_add_u32 v6, 256, v0
  v_lshlrev_b32 v15, 4, v6
  v_cmp_le_u32 vcc, 432, v6
  s_nop 1
  v_cndmask_b32 v7, 0, 1, vcc
  v_mul_u32_u24 v8, 432, v7
  v_sub_u32 v6, v6, v8
  v_mul_u32_u24 v8, 607, v6
  v_lshrrev_b32 v8, 16, v8
  v_mul_u32_u24 v9, 108, v8
  v_sub_u32 v6, v6, v9
  v_lshl_add_u32 v8, v8, 1, v7
  v_mul_u32_u24 v8, 14, v8
  v_lshrrev_b32 v9, 3, v6
  v_add_u32 v8, v8, v9
  v_lshlrev_b32 v8, 6, v8
  v_and_b32 v9, 3, v6
  v_lshl_add_u32 v8, v9, 4, v8
  v_bfe_u32 v9, v6, 2, 1
  v_lshl_add_u32 v8, v9, 3, v8
  v_add_u32 v19, 118784, v8
  v_add_u32 v6, 512, v0
  v_lshlrev_b32 v16, 4, v6
  v_cmp_le_u32 vcc, 432, v6
  s_nop 1
  v_cndmask_b32 v7, 0, 1, vcc
  v_mul_u32_u24 v8, 432, v7
  v_sub_u32 v6, v6, v8
  v_mul_u32_u24 v8, 607, v6
  v_lshrrev_b32 v8, 16, v8
  v_mul_u32_u24 v9, 108, v8
  v_sub_u32 v6, v6, v9
  v_lshl_add_u32 v8, v8, 1, v7
  v_mul_u32_u24 v8, 14, v8
  v_lshrrev_b32 v9, 3, v6
  v_add_u32 v8, v8, v9
  v_lshlrev_b32 v8, 6, v8
  v_and_b32 v9, 3, v6
  v_lshl_add_u32 v8, v9, 4, v8
  v_bfe_u32 v9, v6, 2, 1
  v_lshl_add_u32 v8, v9, 3, v8
  v_add_u32 v20, 118784, v8
  v_add_u32 v6, 768, v0
  v_lshlrev_b32 v17, 4, v6
  v_cmp_le_u32 vcc, 432, v6
  s_nop 1
  v_cndmask_b32 v7, 0, 1, vcc
  v_mul_u32_u24 v8, 432, v7
  v_sub_u32 v6, v6, v8
  v_mul_u32_u24 v8, 607, v6
  v_lshrrev_b32 v8, 16, v8
  v_mul_u32_u24 v9, 108, v8
  v_sub_u32 v6, v6, v9
  v_lshl_add_u32 v8, v8, 1, v7
  v_mul_u32_u24 v8, 14, v8
  v_lshrrev_b32 v9, 3, v6
  v_add_u32 v8, v8, v9
  v_lshlrev_b32 v8, 6, v8
  v_and_b32 v9, 3, v6
  v_lshl_add_u32 v8, v9, 4, v8
  v_bfe_u32 v9, v6, 2, 1
  v_lshl_add_u32 v8, v9, 3, v8
  v_add_u32 v21, 118784, v8
  v_cmp_gt_u32 vcc, 96, v0
  s_nop 1
  v_cndmask_b32 v17, v14, v17, vcc
  v_cndmask_b32 v21, v18, v21, vcc
  v_lshrrev_b32 v6, 2, v1
  v_mul_u32_u24 v6, 896, v6
  v_and_b32 v7, 3, v1
  v_lshl_add_u32 v6, v7, 4, v6
  v_add_u32 v6, 119624, v6
  v_mov_b32 v8, 0
  v_mov_b32 v9, 0
  v_cmp_gt_u32 vcc, 32, v1
  s_nop 0
  s_and_saveexec_b64 s[44:45], vcc
  ds_write_b64 v6, v[8:9]
  s_mov_b64 exec, s[44:45]
  v_and_b32 v6, 1, v2
  s_lshl_b32 s48, s3, 1
  v_add_u32 v6, s48, v6
  v_mul_u32_u24 v6, 896, v6
  v_lshl_add_u32 v22, v3, 4, v6
  v_add_u32 v22, 118784, v22
  v_bfe_u32 v6, v1, 3, 1
  v_and_b32 v7, 7, v1
  v_lshlrev_b32 v7, 4, v7
  v_mul_u32_u24 v8, 10240, v6
  v_add_u32 v24, v8, v7
  v_mul_u32_u24 v8, 2560, v6
  v_add_u32 v25, v8, v7
  v_lshl_add_u32 v26, v6, 7, v7
  v_add_u32 v26, 126976, v26
  v_lshrrev_b32 v27, 1, v25
  s_mul_i32 s48, s3, 28672
  v_add_u32 v6, s48, v10
  s_waitcnt vmcnt(0)
  ds_write_b128 v6, a[0:3] offset:0
  ds_write_b128 v6, a[4:7] offset:1024
  ds_write_b128 v6, a[8:11] offset:2048
  ds_write_b128 v6, a[12:15] offset:3072
  ds_write_b128 v6, a[16:19] offset:4096
  ds_write_b128 v6, a[20:23] offset:5120
  ds_write_b128 v6, a[24:27] offset:6144
  ds_write_b128 v6, a[28:31] offset:7168
  ds_write_b128 v6, a[32:35] offset:8192
  ds_write_b128 v6, a[36:39] offset:9216
  ds_write_b128 v6, a[40:43] offset:10240
  ds_write_b128 v6, a[44:47] offset:11264
  ds_write_b128 v6, a[48:51] offset:12288
  ds_write_b128 v6, a[52:55] offset:13312
  ds_write_b128 v6, a[56:59] offset:14336
  ds_write_b128 v6, a[60:63] offset:15360
  ds_write_b128 v6, a[64:67] offset:16384
  ds_write_b128 v6, a[68:71] offset:17408
  ds_write_b128 v6, a[72:75] offset:18432
  ds_write_b128 v6, a[76:79] offset:19456
  ds_write_b128 v6, a[80:83] offset:20480
  ds_write_b128 v6, a[84:87] offset:21504
  ds_write_b128 v6, a[88:91] offset:22528
  ds_write_b128 v6, a[92:95] offset:23552
  ds_write_b128 v6, a[96:99] offset:24576
  ds_write_b128 v6, a[100:103] offset:25600
  ds_write_b128 v6, a[104:107] offset:26624
  ds_write_b128 v6, a[108:111] offset:27648
  v_lshrrev_b32 v7, 2, v1
  v_lshlrev_b32 v7, 6, v7
  v_and_b32 v8, 3, v1
  v_lshl_add_u32 v7, v8, 3, v7
  v_add_u32 v7, s48, v7
  s_waitcnt lgkmcnt(0)
  ds_read_b64_tr_b16 v[100:101], v7 offset:0
  ds_read_b64_tr_b16 v[102:103], v7 offset:1024
  ds_read_b64_tr_b16 v[104:105], v7 offset:32
  ds_read_b64_tr_b16 v[106:107], v7 offset:1056
  ds_read_b64_tr_b16 v[108:109], v7 offset:2048
  ds_read_b64_tr_b16 v[110:111], v7 offset:3072
  ds_read_b64_tr_b16 v[112:113], v7 offset:2080
  ds_read_b64_tr_b16 v[114:115], v7 offset:3104
  ds_read_b64_tr_b16 v[116:117], v7 offset:4096
  ds_read_b64_tr_b16 v[118:119], v7 offset:5120
  ds_read_b64_tr_b16 v[120:121], v7 offset:4128
  ds_read_b64_tr_b16 v[122:123], v7 offset:5152
  ds_read_b64_tr_b16 v[124:125], v7 offset:6144
  ds_read_b64_tr_b16 v[126:127], v7 offset:7168
  ds_read_b64_tr_b16 v[128:129], v7 offset:6176
  ds_read_b64_tr_b16 v[130:131], v7 offset:7200
  ds_read_b64_tr_b16 v[132:133], v7 offset:8192
  ds_read_b64_tr_b16 v[134:135], v7 offset:9216
  ds_read_b64_tr_b16 v[136:137], v7 offset:8224
  ds_read_b64_tr_b16 v[138:139], v7 offset:9248
  ds_read_b64_tr_b16 v[140:141], v7 offset:10240
  ds_read_b64_tr_b16 v[142:143], v7 offset:11264
  ds_read_b64_tr_b16 v[144:145], v7 offset:10272
  ds_read_b64_tr_b16 v[146:147], v7 offset:11296
  ds_read_b64_tr_b16 v[148:149], v7 offset:12288
  ds_read_b64_tr_b16 v[150:151], v7 offset:13312
  ds_read_b64_tr_b16 v[152:153], v7 offset:12320
  ds_read_b64_tr_b16 v[154:155], v7 offset:13344
  ds_read_b64_tr_b16 v[156:157], v7 offset:14336
  ds_read_b64_tr_b16 v[158:159], v7 offset:15360
  ds_read_b64_tr_b16 v[160:161], v7 offset:14368
  ds_read_b64_tr_b16 v[162:163], v7 offset:15392
  ds_read_b64_tr_b16 v[164:165], v7 offset:16384
  ds_read_b64_tr_b16 v[166:167], v7 offset:17408
  ds_read_b64_tr_b16 v[168:169], v7 offset:16416
  ds_read_b64_tr_b16 v[170:171], v7 offset:17440
  ds_read_b64_tr_b16 v[172:173], v7 offset:18432
  ds_read_b64_tr_b16 v[174:175], v7 offset:19456
  ds_read_b64_tr_b16 v[176:177], v7 offset:18464
  ds_read_b64_tr_b16 v[178:179], v7 offset:19488
  ds_read_b64_tr_b16 v[180:181], v7 offset:20480
  ds_read_b64_tr_b16 v[182:183], v7 offset:21504
  ds_read_b64_tr_b16 v[184:185], v7 offset:20512
  ds_read_b64_tr_b16 v[186:187], v7 offset:21536
  ds_read_b64_tr_b16 v[188:189], v7 offset:22528
  ds_read_b64_tr_b16 v[190:191], v7 offset:23552
  ds_read_b64_tr_b16 v[192:193], v7 offset:22560
  ds_read_b64_tr_b16 v[194:195], v7 offset:23584
  ds_read_b64_tr_b16 v[196:197], v7 offset:24576
  ds_read_b64_tr_b16 v[198:199], v7 offset:25600
  ds_read_b64_tr_b16 v[200:201], v7 offset:24608
  ds_read_b64_tr_b16 v[202:203], v7 offset:25632
  ds_read_b64_tr_b16 v[204:205], v7 offset:26624
  ds_read_b64_tr_b16 v[206:207], v7 offset:27648
  ds_read_b64_tr_b16 v[208:209], v7 offset:26656
  ds_read_b64_tr_b16 v[210:211], v7 offset:27680
  s_cmp_lg_u32 s3, 0
  s_cbranch_scc1 L_sk_112
  v_cmp_gt_u32 vcc, 16, v1
  s_nop 0
  s_and_saveexec_b64 s[44:45], vcc
  s_lshl_b32 s48, s23, 7
  s_add_u32 s60, s48, 138752
  s_add_u32 s61, s60, 20480
  s_add_u32 s62, s48, 884736
  buffer_load_dwordx4 v[224:227], v24, s[8:11], s60 offen sc1
  buffer_load_dwordx4 v[228:231], v24, s[8:11], s61 offen sc1
  v_mov_b32 v6, 0
  s_waitcnt vmcnt(1)
  v_msad_u8 v6, v224, v4, v6
  v_msad_u8 v6, v225, v4, v6
  v_msad_u8 v6, v226, v4, v6
  v_msad_u8 v6, v227, v4, v6
  s_waitcnt vmcnt(0)
  v_msad_u8 v6, v228, v4, v6
  v_msad_u8 v6, v229, v4, v6
  v_msad_u8 v6, v230, v4, v6
  v_msad_u8 v6, v231, v4, v6
  v_cmp_ne_u32 vcc, 0, v6
  s_nop 0
  s_cbranch_vccz L_pld_113
L_pls_114:
  s_mov_b32 s100, 0
  v_mov_b32 v6, 0
  v_msad_u8 v6, v224, v4, v6
  v_msad_u8 v6, v225, v4, v6
  v_msad_u8 v6, v226, v4, v6
  v_msad_u8 v6, v227, v4, v6
  v_cmp_ne_u32 vcc, 0, v6
  s_nop 0
  s_cbranch_vccz L_plk_115
  buffer_load_dwordx4 v[224:227], v24, s[8:11], s60 offen sc1
  s_mov_b32 s100, 1
L_plk_115:
  v_mov_b32 v6, 0
  v_msad_u8 v6, v228, v4, v6
  v_msad_u8 v6, v229, v4, v6
  v_msad_u8 v6, v230, v4, v6
  v_msad_u8 v6, v231, v4, v6
  v_cmp_ne_u32 vcc, 0, v6
  s_nop 0
  s_cbranch_vccz L_plk_116
  buffer_load_dwordx4 v[228:231], v24, s[8:11], s61 offen sc1
  s_mov_b32 s100, 1
L_plk_116:
  s_cmp_eq_u32 s100, 0
  s_cbranch_scc1 L_pld_113
  s_waitcnt vmcnt(0)
  s_add_u32 s15, s15, 1
  s_cmp_lt_u32 s15, 100000
  s_cbranch_scc1 L_pls_114
L_pld_113:
  v_add_f32 v224, v224, v228
  v_cvt_pk_bf16_f32 v224, v224, v224
  v_and_b32 v224, 0xffff0000, v224
  v_add_f32 v225, v225, v229
  v_cvt_pk_bf16_f32 v225, v225, v225
  v_and_b32 v225, 0xffff0000, v225
  v_add_f32 v226, v226, v230
  v_cvt_pk_bf16_f32 v226, v226, v226
  v_and_b32 v226, 0xffff0000, v226
  v_add_f32 v227, v227, v231
  v_cvt_pk_bf16_f32 v227, v227, v227
  v_and_b32 v227, 0xffff0000, v227
  s_mov_b64 exec, s[44:45]
L_sk_112:
  s_mov_b32 s63, 851968
  s_mov_b32 s48, 11264
  v_and_b32 v7, 7, v1
  v_lshlrev_b32 v7, 7, v7
L_db_117:
  buffer_load_dword v6, v7, s[8:11], s48 offen sc1
  s_waitcnt vmcnt(0)
  v_cmp_ne_u32 vcc, s13, v6
  s_nop 0
  s_cbranch_vccz L_dbd_118
  s_sleep 1
  s_add_u32 s15, s15, 1
  s_cmp_lt_u32 s15, 100000
  s_cbranch_scc1 L_db_117
L_dbd_118:
  s_cmp_ge_u32 s3, 2
  s_cbranch_scc1 L_h2_120
  s_cmp_eq_u32 s3, 0
  s_cbranch_scc1 L_h0_121
  buffer_load_dwordx4 v[40:43], v14, s[8:11], s63 offen sc1
  buffer_load_dwordx4 v[44:47], v15, s[8:11], s63 offen sc1
  buffer_load_dwordx4 v[48:51], v16, s[8:11], s63 offen sc1
  buffer_load_dwordx4 v[52:55], v17, s[8:11], s63 offen sc1
  v_mov_b32 v6, 0
  s_waitcnt vmcnt(3)
  v_msad_u8 v6, v40, v4, v6
  v_msad_u8 v6, v41, v4, v6
  v_msad_u8 v6, v42, v4, v6
  v_msad_u8 v6, v43, v4, v6
  s_waitcnt vmcnt(2)
  v_msad_u8 v6, v44, v4, v6
  v_msad_u8 v6, v45, v4, v6
  v_msad_u8 v6, v46, v4, v6
  v_msad_u8 v6, v47, v4, v6
  s_waitcnt vmcnt(1)
  v_msad_u8 v6, v48, v4, v6
  v_msad_u8 v6, v49, v4, v6
  v_msad_u8 v6, v50, v4, v6
  v_msad_u8 v6, v51, v4, v6
  s_waitcnt vmcnt(0)
  v_msad_u8 v6, v52, v4, v6
  v_msad_u8 v6, v53, v4, v6
  v_msad_u8 v6, v54, v4, v6
  v_msad_u8 v6, v55, v4, v6
  v_cmp_ne_u32 vcc, 0, v6
  s_nop 0
  s_cbranch_vccz L_pld_122
L_pls_123:
  s_mov_b32 s100, 0
  v_mov_b32 v6, 0
  v_msad_u8 v6, v40, v4, v6
  v_msad_u8 v6, v41, v4, v6
  v_msad_u8 v6, v42, v4, v6
  v_msad_u8 v6, v43, v4, v6
  v_cmp_ne_u32 vcc, 0, v6
  s_nop 0
  s_cbranch_vccz L_plk_124
  buffer_load_dwordx4 v[40:43], v14, s[8:11], s63 offen sc1
  s_mov_b32 s100, 1
L_plk_124:
  v_mov_b32 v6, 0
  v_msad_u8 v6, v44, v4, v6
  v_msad_u8 v6, v45, v4, v6
  v_msad_u8 v6, v46, v4, v6
  v_msad_u8 v6, v47, v4, v6
  v_cmp_ne_u32 vcc, 0, v6
  s_nop 0
  s_cbranch_vccz L_plk_125
  buffer_load_dwordx4 v[44:47], v15, s[8:11], s63 offen sc1
  s_mov_b32 s100, 1
L_plk_125:
  v_mov_b32 v6, 0
  v_msad_u8 v6, v48, v4, v6
  v_msad_u8 v6, v49, v4, v6
  v_msad_u8 v6, v50, v4, v6
  v_msad_u8 v6, v51, v4, v6
  v_cmp_ne_u32 vcc, 0, v6
  s_nop 0
  s_cbranch_vccz L_plk_126
  buffer_load_dwordx4 v[48:51], v16, s[8:11], s63 offen sc1
  s_mov_b32 s100, 1
L_plk_126:
  v_mov_b32 v6, 0
  v_msad_u8 v6, v52, v4, v6
  v_msad_u8 v6, v53, v4, v6
  v_msad_u8 v6, v54, v4, v6
  v_msad_u8 v6, v55, v4, v6
  v_cmp_ne_u32 vcc, 0, v6
  s_nop 0
  s_cbranch_vccz L_plk_127
  buffer_load_dwordx4 v[52:55], v17, s[8:11], s63 offen sc1
  s_mov_b32 s100, 1
L_plk_127:
  s_cmp_eq_u32 s100, 0
  s_cbranch_scc1 L_pld_122
  s_waitcnt vmcnt(0)
  s_add_u32 s15, s15, 1
  s_cmp_lt_u32 s15, 100000
  s_cbranch_scc1 L_pls_123
L_pld_122:
  v_cvt_pk_bf16_f32 v40, v40, v41
  v_cvt_pk_bf16_f32 v41, v42, v43
  ds_write_b64 v18, v[40:41]
  v_cvt_pk_bf16_f32 v44, v44, v45
  v_cvt_pk_bf16_f32 v45, v46, v47
  ds_write_b64 v19, v[44:45]
  v_cvt_pk_bf16_f32 v48, v48, v49
  v_cvt_pk_bf16_f32 v49, v50, v51
  ds_write_b64 v20, v[48:49]
  v_cvt_pk_bf16_f32 v52, v52, v53
  v_cvt_pk_bf16_f32 v53, v54, v55
  ds_write_b64 v21, v[52:53]
  s_branch L_hj_119
L_h0_121:
  buffer_load_dwordx4 v[40:43], v14, s[8:11], s63 offen sc1
  buffer_load_dwordx4 v[44:47], v15, s[8:11], s63 offen sc1
  buffer_load_dwordx4 v[48:51], v16, s[8:11], s63 offen sc1
  buffer_load_dwordx4 v[52:55], v17, s[8:11], s63 offen sc1
  buffer_load_dwordx4 v[36:39], v25, s[8:11], s62 offen sc1
  v_mov_b32 v6, 0
  s_waitcnt vmcnt(4)
  v_msad_u8 v6, v40, v4, v6
  v_msad_u8 v6, v41, v4, v6
  v_msad_u8 v6, v42, v4, v6
  v_msad_u8 v6, v43, v4, v6
  s_waitcnt vmcnt(3)
  v_msad_u8 v6, v44, v4, v6
  v_msad_u8 v6, v45, v4, v6
  v_msad_u8 v6, v46, v4, v6
  v_msad_u8 v6, v47, v4, v6
  s_waitcnt vmcnt(2)
  v_msad_u8 v6, v48, v4, v6
  v_msad_u8 v6, v49, v4, v6
  v_msad_u8 v6, v50, v4, v6
  v_msad_u8 v6, v51, v4, v6
  s_waitcnt vmcnt(1)
  v_msad_u8 v6, v52, v4, v6
  v_msad_u8 v6, v53, v4, v6
  v_msad_u8 v6, v54, v4, v6
  v_msad_u8 v6, v55, v4, v6
  s_waitcnt vmcnt(0)
  v_msad_u8 v6, v36, v4, v6
  v_msad_u8 v6, v37, v4, v6
  v_msad_u8 v6, v38, v4, v6
  v_msad_u8 v6, v39, v4, v6
  v_cmp_ne_u32 vcc, 0, v6
  s_nop 0
  s_cbranch_vccz L_pld_128
L_pls_129:
  s_mov_b32 s100, 0
  v_mov_b32 v6, 0
  v_msad_u8 v6, v40, v4, v6
  v_msad_u8 v6, v41, v4, v6
  v_msad_u8 v6, v42, v4, v6
  v_msad_u8 v6, v43, v4, v6
  v_cmp_ne_u32 vcc, 0, v6
  s_nop 0
  s_cbranch_vccz L_plk_130
  buffer_load_dwordx4 v[40:43], v14, s[8:11], s63 offen sc1
  s_mov_b32 s100, 1
L_plk_130:
  v_mov_b32 v6, 0
  v_msad_u8 v6, v44, v4, v6
  v_msad_u8 v6, v45, v4, v6
  v_msad_u8 v6, v46, v4, v6
  v_msad_u8 v6, v47, v4, v6
  v_cmp_ne_u32 vcc, 0, v6
  s_nop 0
  s_cbranch_vccz L_plk_131
  buffer_load_dwordx4 v[44:47], v15, s[8:11], s63 offen sc1
  s_mov_b32 s100, 1
L_plk_131:
  v_mov_b32 v6, 0
  v_msad_u8 v6, v48, v4, v6
  v_msad_u8 v6, v49, v4, v6
  v_msad_u8 v6, v50, v4, v6
  v_msad_u8 v6, v51, v4, v6
  v_cmp_ne_u32 vcc, 0, v6
  s_nop 0
  s_cbranch_vccz L_plk_132
  buffer_load_dwordx4 v[48:51], v16, s[8:11], s63 offen sc1
  s_mov_b32 s100, 1
L_plk_132:
  v_mov_b32 v6, 0
  v_msad_u8 v6, v52, v4, v6
  v_msad_u8 v6, v53, v4, v6
  v_msad_u8 v6, v54, v4, v6
  v_msad_u8 v6, v55, v4, v6
  v_cmp_ne_u32 vcc, 0, v6
  s_nop 0
  s_cbranch_vccz L_plk_133
  buffer_load_dwordx4 v[52:55], v17, s[8:11], s63 offen sc1
  s_mov_b32 s100, 1
L_plk_133:
  v_mov_b32 v6, 0
  v_msad_u8 v6, v36, v4, v6
  v_msad_u8 v6, v37, v4, v6
  v_msad_u8 v6, v38, v4, v6
  v_msad_u8 v6, v39, v4, v6
  v_cmp_ne_u32 vcc, 0, v6
  s_nop 0
  s_cbranch_vccz L_plk_134
  buffer_load_dwordx4 v[36:39], v25, s[8:11], s62 offen sc1
  s_mov_b32 s100, 1
L_plk_134:
  s_cmp_eq_u32 s100, 0
  s_cbranch_scc1 L_pld_128
  s_waitcnt vmcnt(0)
  s_add_u32 s15, s15, 1
  s_cmp_lt_u32 s15, 100000
  s_cbranch_scc1 L_pls_129
L_pld_128:
  v_cvt_pk_bf16_f32 v40, v40, v41
  v_cvt_pk_bf16_f32 v41, v42, v43
  ds_write_b64 v18, v[40:41]
  v_cvt_pk_bf16_f32 v44, v44, v45
  v_cvt_pk_bf16_f32 v45, v46, v47
  ds_write_b64 v19, v[44:45]
  v_cvt_pk_bf16_f32 v48, v48, v49
  v_cvt_pk_bf16_f32 v49, v50, v51
  ds_write_b64 v20, v[48:49]
  v_cvt_pk_bf16_f32 v52, v52, v53
  v_cvt_pk_bf16_f32 v53, v54, v55
  ds_write_b64 v21, v[52:53]
  s_branch L_hj_119
L_h2_120:
  buffer_load_dwordx4 v[40:43], v14, s[8:11], s63 offen sc1
  buffer_load_dwordx4 v[44:47], v15, s[8:11], s63 offen sc1
  buffer_load_dwordx4 v[48:51], v16, s[8:11], s63 offen sc1
  v_mov_b32 v6, 0
  s_waitcnt vmcnt(2)
  v_msad_u8 v6, v40, v4, v6
  v_msad_u8 v6, v41, v4, v6
  v_msad_u8 v6, v42, v4, v6
  v_msad_u8 v6, v43, v4, v6
  s_waitcnt vmcnt(1)
  v_msad_u8 v6, v44, v4, v6
  v_msad_u8 v6, v45, v4, v6
  v_msad_u8 v6, v46, v4, v6
  v_msad_u8 v6, v47, v4, v6
  s_waitcnt vmcnt(0)
  v_msad_u8 v6, v48, v4, v6
  v_msad_u8 v6, v49, v4, v6
  v_msad_u8 v6, v50, v4, v6
  v_msad_u8 v6, v51, v4, v6
  v_cmp_ne_u32 vcc, 0, v6
  s_nop 0
  s_cbranch_vccz L_pld_135
L_pls_136:
  s_mov_b32 s100, 0
  v_mov_b32 v6, 0
  v_msad_u8 v6, v40, v4, v6
  v_msad_u8 v6, v41, v4, v6
  v_msad_u8 v6, v42, v4, v6
  v_msad_u8 v6, v43, v4, v6
  v_cmp_ne_u32 vcc, 0, v6
  s_nop 0
  s_cbranch_vccz L_plk_137
  buffer_load_dwordx4 v[40:43], v14, s[8:11], s63 offen sc1
  s_mov_b32 s100, 1
L_plk_137:
  v_mov_b32 v6, 0
  v_msad_u8 v6, v44, v4, v6
  v_msad_u8 v6, v45, v4, v6
  v_msad_u8 v6, v46, v4, v6
  v_msad_u8 v6, v47, v4, v6
  v_cmp_ne_u32 vcc, 0, v6
  s_nop 0
  s_cbranch_vccz L_plk_138
  buffer_load_dwordx4 v[44:47], v15, s[8:11], s63 offen sc1
  s_mov_b32 s100, 1
L_plk_138:
  v_mov_b32 v6, 0
  v_msad_u8 v6, v48, v4, v6
  v_msad_u8 v6, v49, v4, v6
  v_msad_u8 v6, v50, v4, v6
  v_msad_u8 v6, v51, v4, v6
  v_cmp_ne_u32 vcc, 0, v6
  s_nop 0
  s_cbranch_vccz L_plk_139
  buffer_load_dwordx4 v[48:51], v16, s[8:11], s63 offen sc1
  s_mov_b32 s100, 1
L_plk_139:
  s_cmp_eq_u32 s100, 0
  s_cbranch_scc1 L_pld_135
  s_waitcnt vmcnt(0)
  s_add_u32 s15, s15, 1
  s_cmp_lt_u32 s15, 100000
  s_cbranch_scc1 L_pls_136
L_pld_135:
  v_cvt_pk_bf16_f32 v40, v40, v41
  v_cvt_pk_bf16_f32 v41, v42, v43
  ds_write_b64 v18, v[40:41]
  v_cvt_pk_bf16_f32 v44, v44, v45
  v_cvt_pk_bf16_f32 v45, v46, v47
  ds_write_b64 v19, v[44:45]
  v_cvt_pk_bf16_f32 v48, v48, v49
  v_cvt_pk_bf16_f32 v49, v50, v51
  ds_write_b64 v20, v[48:49]
L_hj_119:
  s_waitcnt lgkmcnt(0)
  s_barrier
  ds_read_b128 v[40:43], v22 offset:0
  ds_read_b128 v[44:47], v22 offset:64
  ds_read_b128 v[48:51], v22 offset:128
  ds_read_b128 v[52:55], v22 offset:192
  ds_read_b128 v[56:59], v22 offset:256
  ds_read_b128 v[60:63], v22 offset:320
  ds_read_b128 v[64:67], v22 offset:384
  ds_read_b128 v[68:71], v22 offset:448
  ds_read_b128 v[72:75], v22 offset:512
  ds_read_b128 v[76:79], v22 offset:576
  ds_read_b128 v[80:83], v22 offset:640
  ds_read_b128 v[84:87], v22 offset:704
  ds_read_b128 v[88:91], v22 offset:768
  ds_read_b128 v[92:95], v22 offset:832
  v_mov_b32 v216, 0
  v_mov_b32 v217, 0
  v_mov_b32 v218, 0
  v_mov_b32 v219, 0
  v_mov_b32 v220, 0
  v_mov_b32 v221, 0
  v_mov_b32 v222, 0
  v_mov_b32 v223, 0
  s_waitcnt lgkmcnt(13)
  v_mfma_f32_16x16x32_bf16 v[216:219], v[40:43], v[100:103], v[216:219]
  v_mfma_f32_16x16x32_bf16 v[220:223], v[40:43], v[104:107], v[220:223]
  s_waitcnt lgkmcnt(12)
  v_mfma_f32_16x16x32_bf16 v[216:219], v[44:47], v[108:111], v[216:219]
  v_mfma_f32_16x16x32_bf16 v[220:223], v[44:47], v[112:115], v[220:223]
  s_waitcnt lgkmcnt(11)
  v_mfma_f32_16x16x32_bf16 v[216:219], v[48:51], v[116:119], v[216:219]
  v_mfma_f32_16x16x32_bf16 v[220:223], v[48:51], v[120:123], v[220:223]
  s_waitcnt lgkmcnt(10)
  v_mfma_f32_16x16x32_bf16 v[216:219], v[52:55], v[124:127], v[216:219]
  v_mfma_f32_16x16x32_bf16 v[220:223], v[52:55], v[128:131], v[220:223]
  s_waitcnt lgkmcnt(9)
  v_mfma_f32_16x16x32_bf16 v[216:219], v[56:59], v[132:135], v[216:219]
  v_mfma_f32_16x16x32_bf16 v[220:223], v[56:59], v[136:139], v[220:223]
  s_waitcnt lgkmcnt(8)
  v_mfma_f32_16x16x32_bf16 v[216:219], v[60:63], v[140:143], v[216:219]
  v_mfma_f32_16x16x32_bf16 v[220:223], v[60:63], v[144:147], v[220:223]
  s_waitcnt lgkmcnt(7)
  v_mfma_f32_16x16x32_bf16 v[216:219], v[64:67], v[148:151], v[216:219]
  v_mfma_f32_16x16x32_bf16 v[220:223], v[64:67], v[152:155], v[220:223]
  s_waitcnt lgkmcnt(6)
  v_mfma_f32_16x16x32_bf16 v[216:219], v[68:71], v[156:159], v[216:219]
  v_mfma_f32_16x16x32_bf16 v[220:223], v[68:71], v[160:163], v[220:223]
  s_waitcnt lgkmcnt(5)
  v_mfma_f32_16x16x32_bf16 v[216:219], v[72:75], v[164:167], v[216:219]
  v_mfma_f32_16x16x32_bf16 v[220:223], v[72:75], v[168:171], v[220:223]
  s_waitcnt lgkmcnt(4)
  v_mfma_f32_16x16x32_bf16 v[216:219], v[76:79], v[172:175], v[216:219]
  v_mfma_f32_16x16x32_bf16 v[220:223], v[76:79], v[176:179], v[220:223]
  s_waitcnt lgkmcnt(3)
  v_mfma_f32_16x16x32_bf16 v[216:219], v[80:83], v[180:183], v[216:219]
  v_mfma_f32_16x16x32_bf16 v[220:223], v[80:83], v[184:187], v[220:223]
  s_waitcnt lgkmcnt(2)
  v_mfma_f32_16x16x32_bf16 v[216:219], v[84:87], v[188:191], v[216:219]
  v_mfma_f32_16x16x32_bf16 v[220:223], v[84:87], v[192:195], v[220:223]
  s_waitcnt lgkmcnt(1)
  v_mfma_f32_16x16x32_bf16 v[216:219], v[88:91], v[196:199], v[216:219]
  v_mfma_f32_16x16x32_bf16 v[220:223], v[88:91], v[200:203], v[220:223]
  s_waitcnt lgkmcnt(0)
  v_mfma_f32_16x16x32_bf16 v[216:219], v[92:95], v[204:207], v[216:219]
  v_mfma_f32_16x16x32_bf16 v[220:223], v[92:95], v[208:211], v[220:223]
  s_lshl_b32 s48, s3, 8
  s_add_u32 s48, s48, 126976
  v_lshlrev_b32 v6, 2, v1
  v_add_u32 v6, s48, v6
  v_cmp_gt_u32 vcc, 16, v1
  s_nop 0
  s_and_saveexec_b64 s[44:45], vcc
  ds_write_b32 v6, v216
  ds_write_b32 v6, v217 offset:128
  ds_write_b32 v6, v220 offset:64
  ds_write_b32 v6, v221 offset:192
  s_mov_b64 exec, s[44:45]
  s_waitcnt lgkmcnt(0)
  s_barrier
  s_cmp_lg_u32 s3, 0
  s_cbranch_scc1 L_END
  v_cmp_gt_u32 vcc, 16, v1
  s_nop 0
  s_and_saveexec_b64 s[44:45], vcc
  ds_read_b128 v[40:43], v26 offset:0
  ds_read_b128 v[44:47], v26 offset:256
  ds_read_b128 v[48:51], v26 offset:512
  ds_read_b128 v[52:55], v26 offset:768
  s_waitcnt lgkmcnt(0)
  v_add_f32 v40, v40, v44
  v_add_f32 v48, v48, v52
  v_add_f32 v40, v40, v48
  v_cvt_pk_bf16_f32 v40, v40, v40
  v_and_b32 v40, 0xffff0000, v40
  v_mul_f32 v40, v224, v40
  v_cvt_pk_bf16_f32 v40, v40, v40
  v_and_b32 v40, 0xffff0000, v40
  v_and_b32 v36, 0xffff0000, v36
  v_add_f32 v40, v36, v40
  v_add_f32 v41, v41, v45
  v_add_f32 v49, v49, v53
  v_add_f32 v41, v41, v49
  v_cvt_pk_bf16_f32 v41, v41, v41
  v_and_b32 v41, 0xffff0000, v41
  v_mul_f32 v41, v225, v41
  v_cvt_pk_bf16_f32 v41, v41, v41
  v_and_b32 v41, 0xffff0000, v41
  v_and_b32 v37, 0xffff0000, v37
  v_add_f32 v41, v37, v41
  v_add_f32 v42, v42, v46
  v_add_f32 v50, v50, v54
  v_add_f32 v42, v42, v50
  v_cvt_pk_bf16_f32 v42, v42, v42
  v_and_b32 v42, 0xffff0000, v42
  v_mul_f32 v42, v226, v42
  v_cvt_pk_bf16_f32 v42, v42, v42
  v_and_b32 v42, 0xffff0000, v42
  v_and_b32 v38, 0xffff0000, v38
  v_add_f32 v42, v38, v42
  v_add_f32 v43, v43, v47
  v_add_f32 v51, v51, v55
  v_add_f32 v43, v43, v51
  v_cvt_pk_bf16_f32 v43, v43, v43
  v_and_b32 v43, 0xffff0000, v43
  v_mul_f32 v43, v227, v43
  v_cvt_pk_bf16_f32 v43, v43, v43
  v_and_b32 v43, 0xffff0000, v43
  v_and_b32 v39, 0xffff0000, v39
  v_add_f32 v43, v39, v43
  v_cvt_pk_bf16_f32 v40, v40, v41
  v_cvt_pk_bf16_f32 v41, v42, v43
  s_lshl_b32 s48, s23, 6
  buffer_store_dwordx2 v[40:41], v27, s[64:67], s48 offen
  s_mov_b64 exec, s[44:45]
  s_cmp_lg_u32 s23, 0
  s_cbranch_scc1 L_END
  s_mov_b64 exec, 1
  buffer_store_dword v4, v5, s[8:11], 0 offen
  s_endpgm
L_END:
  s_endpgm
.section .rodata,"a"
.p2align 6
.amdhsa_kernel adaLN_cond__compressed_kv_cla__glu_gated_glu__decode_kernel
  .amdhsa_next_free_vgpr 512
  .amdhsa_next_free_sgpr 102
  .amdhsa_accum_offset 256
  .amdhsa_group_segment_fixed_size 0
  .amdhsa_kernarg_size 120
  .amdhsa_user_sgpr_count 2
  .amdhsa_user_sgpr_kernarg_segment_ptr 1
  .amdhsa_system_sgpr_workgroup_id_x 1
.end_amdhsa_kernel
```
